```python
import torch

def _softmax(x, axis=-1):
    return torch.softmax(x, dim=axis)
def _gelu(x):
    return torch.nn.functional.gelu(x, approximate="tanh")
def _silu(x):
    return torch.nn.functional.silu(x)
def _sigmoid(x):
    return torch.sigmoid(x)
def _layernorm(x, axis=-1, eps=1e-5):
    m = x.mean(dim=axis, keepdim=True)
    v = x.var(dim=axis, keepdim=True, unbiased=False)
    return (x - m) / torch.sqrt(v + eps)
def _scatter_add(tgt, idx, src, axis=0):
    return tgt.clone().index_add_(axis, idx, src)
def _segment_sum(src, seg, n):
    out = torch.zeros((n,) + src.shape[1:], dtype=src.dtype)
    return out.index_add_(0, seg, src)
def _pad(x, pw):
    flat = tuple(v for pair in reversed(pw) for v in pair)
    return torch.nn.functional.pad(x, flat)

kernel_name = 'standalone__gqa_block_cached__near_ridge'

def setup_inputs():

    _w = (lambda a: (lambda t: t.to(torch.bfloat16) if t.is_floating_point() else t)(torch.as_tensor(a)))
    B, Sq, D = 8, 240, 512
    Hq, Hkv, Sk, Dh = 32, 32, 512, 128
    assert Hq % Hkv == 0, (Hq, Hkv)
    return {
        "x": _w((lambda *s: torch.randn(*s, dtype=torch.bfloat16) * 0.8)(B, Sq, D)),
        "k_cache": _w((lambda *s: torch.randn(*s, dtype=torch.bfloat16) * 0.8)(B, Hkv, Sk, Dh)),
        "v_cache": _w((lambda *s: torch.randn(*s, dtype=torch.bfloat16) * 0.05)(B, Hkv, Sk, Dh)),
        "wq": _w((lambda *s: torch.randn(*s, dtype=torch.bfloat16) * 0.8)(D, Hq * Dh) * (D ** -0.5)),
        "wo": _w((lambda *s: torch.randn(*s, dtype=torch.bfloat16) * 0.05)(Hq * Dh, D) * ((Hq * Dh) ** -0.5)),
    }

def reference(x, k_cache, v_cache, wq, wo):
    B, Sq, D = x.shape
    Hq, Dh = 32, 128
    Hkv = k_cache.shape[1]
    rep = Hq // Hkv
    q = (lambda x, *d: x.permute(*d))((x @ wq).reshape(B, Sq, Hq, Dh), 0, 2, 1, 3)
    k = (lambda x, n, axis: torch.repeat_interleave(x, n, dim=axis))(k_cache, rep, axis=1)
    v = (lambda x, n, axis: torch.repeat_interleave(x, n, dim=axis))(v_cache, rep, axis=1)
    scores = torch.einsum("bhqd,bhkd->bhqk", q, k) * (Dh ** -0.5)
    p = _softmax(scores, axis=-1)
    o = torch.einsum("bhqk,bhkd->bhqd", p, v)
    return (lambda x, *d: x.permute(*d))(o, 0, 2, 1, 3).reshape(B, Sq, Hq * Dh) @ wo
```

```asm
; @launch grid=(256,1,1) block=(512,1,1) lds=163840
.amdgcn_target "amdgcn-amd-amdhsa--gfx950"
.text
.globl standalone__gqa_block_cached__near_ridge_kernel
.p2align 8
.type standalone__gqa_block_cached__near_ridge_kernel,@function
standalone__gqa_block_cached__near_ridge_kernel:
    s_cmp_ge_u32 s2, 256
    s_cbranch_scc1 L_end
    s_load_dwordx16 s[4:19], s[0:1], 0
    v_and_b32 v1, 63, v0
    v_lshrrev_b32 v15, 6, v0
    s_nop 0
    v_readfirstlane_b32 s62, v15
    s_and_b32 s63, s2, 7
    s_lshr_b32 s64, s2, 3
    s_and_b32 s60, s63, 1
    s_lshl_b32 s60, s60, 2
    s_and_b32 s66, s64, 3
    s_add_u32 s60, s60, s66
    s_lshr_b32 s61, s63, 1
    s_lshl_b32 s61, s61, 3
    s_lshr_b32 s66, s64, 2
    s_add_u32 s61, s61, s66
    s_and_b32 s101, s62, 3
    s_mul_i32 s69, s101, 4352
    s_cmp_lt_u32 s62, 4
    s_cbranch_scc1 L_compute
    v_bfe_u32 v232, v1, 2, 2
    v_lshrrev_b32 v233, 4, v1
    v_and_b32 v234, 3, v1
    v_lshlrev_b32 v234, 4, v234
    v_lshl_add_u32 v234, v233, 6, v234
    v_lshl_add_u32 v12, v232, 13, v234
    v_xor_b32 v13, 32, v12
    v_lshrrev_b32 v232, 3, v1
    v_and_b32 v234, 7, v1
    v_xor_b32 v234, v234, v233
    v_lshlrev_b32 v234, 4, v234
    v_lshl_add_u32 v14, v232, 10, v234
    s_lshl_b32 s70, s101, 15
    s_lshl_b32 s71, s101, 17
    s_lshl_b32 s100, s101, 12
    s_mul_i32 s63, s60, 245760
    s_lshl_b32 s64, s61, 8
    s_add_u32 s3, s60, s61
    s_and_b32 s3, s3, 3
    s_lshl_b32 s3, s3, 1
    s_waitcnt lgkmcnt(0)
    s_add_u32 s32, s10, s64
    s_addc_u32 s33, s11, 0
    s_sub_u32 s34, 4194304, s64
    s_mov_b32 s35, 0x00020000
    s_add_u32 s20, s4, s63
    s_addc_u32 s21, s5, 0
    s_mov_b32 s22, 245760
    s_mov_b32 s23, 0x00020000
    s_add_u32 s63, s3, 0
    s_and_b32 s63, s63, 7
    s_lshl_b32 s64, s63, 19
    s_add_u32 s64, s64, s71
    s_lshl_b32 s63, s63, 7
    s_add_u32 s63, s63, s70
    s_add_u32 m0, s100, 120832
    s_add_u32 s72, s64, 0
    buffer_load_dwordx4 v12, s[32:35], s72 offen lds
    s_add_u32 m0, s100, 121856
    s_add_u32 s72, s64, 32768
    buffer_load_dwordx4 v12, s[32:35], s72 offen lds
    s_add_u32 m0, s100, 122880
    s_add_u32 s72, s64, 65536
    buffer_load_dwordx4 v13, s[32:35], s72 offen lds
    s_add_u32 m0, s100, 123904
    s_add_u32 s72, s64, 98304
    buffer_load_dwordx4 v13, s[32:35], s72 offen lds
    s_add_u32 m0, s69, 86016
    s_add_u32 s73, s63, 0
    buffer_load_dwordx4 v14, s[20:23], s73 offen lds
    s_add_u32 m0, s69, 87104
    s_add_u32 s73, s63, 8192
    buffer_load_dwordx4 v14, s[20:23], s73 offen lds
    s_add_u32 m0, s69, 88192
    s_add_u32 s73, s63, 16384
    buffer_load_dwordx4 v14, s[20:23], s73 offen lds
    s_add_u32 m0, s69, 89280
    s_add_u32 s73, s63, 24576
    buffer_load_dwordx4 v14, s[20:23], s73 offen lds
    s_add_u32 m0, s69, 103424
    s_add_u32 s73, s63, 131072
    buffer_load_dwordx4 v14, s[20:23], s73 offen lds
    s_add_u32 m0, s69, 104512
    s_add_u32 s73, s63, 139264
    buffer_load_dwordx4 v14, s[20:23], s73 offen lds
    s_add_u32 m0, s69, 105600
    s_add_u32 s73, s63, 147456
    buffer_load_dwordx4 v14, s[20:23], s73 offen lds
    s_add_u32 m0, s69, 106688
    s_add_u32 s73, s63, 155648
    buffer_load_dwordx4 v14, s[20:23], s73 offen lds
    s_lshl_b32 s63, s60, 5
    s_add_u32 s63, s63, s61
    s_lshl_b32 s63, s63, 17
    s_add_u32 s24, s6, s63
    s_addc_u32 s25, s7, 0
    s_mov_b32 s26, 131072
    s_mov_b32 s27, 0x00020000
    s_add_u32 s28, s8, s63
    s_addc_u32 s29, s9, 0
    s_mov_b32 s30, 131072
    s_mov_b32 s31, 0x00020000
    v_bfe_u32 v232, v1, 2, 2
    v_lshrrev_b32 v233, 4, v1
    v_and_b32 v234, 3, v1
    v_lshlrev_b32 v234, 4, v234
    v_lshl_add_u32 v234, v233, 6, v234
    v_lshl_add_u32 v3, v232, 8, v234
    v_xor_b32 v4, 32, v3
    v_and_b32 v234, 15, v1
    v_xor_b32 v234, v234, v233
    v_lshlrev_b32 v234, 4, v234
    v_lshl_add_u32 v2, v233, 8, v234
    s_mul_i32 s65, s62, 2176
    s_lshl_b32 s68, s62, 11
    s_mov_b32 s63, 16777216
    s_add_u32 s56, s18, s63
    s_addc_u32 s57, s19, 0
    s_mov_b32 s58, 32768
    s_mov_b32 s59, 0x00020000
    s_mov_b32 s48, s16
    s_mov_b32 s49, s17
    s_mov_b32 s50, 256
    s_mov_b32 s51, 0x00020000
    s_lshl_b32 s63, s60, 3
    s_lshr_b32 s64, s61, 2
    s_add_u32 s63, s63, s64
    s_lshl_b32 s63, s63, 2
    s_lshr_b32 s64, s62, 1
    s_add_u32 s63, s63, s64
    s_lshl_b32 s63, s63, 7
    s_and_b32 s64, s61, 3
    s_lshl_b32 s64, s64, 3
    s_add_u32 s63, s63, s64
    s_and_b32 s64, s62, 1
    s_lshl_b32 s64, s64, 2
    s_add_u32 s63, s63, s64
    v_mov_b32 v232, 0x7ffffff0
    v_mov_b32 v233, s63
    v_cmp_eq_u32 vcc, 0, v1
    v_mov_b32 v8, 0
    v_mov_b32 v9, 0
    s_lshl_b32 s64, s60, 5
    s_add_u32 s64, s64, 16
    v_mov_b32 v234, s64
    v_cndmask_b32 v243, v232, v233, vcc
    buffer_store_dword v8, v243, s[56:59], 0 offen sc1
    v_cmp_eq_u32 vcc, 0, v0
    v_mov_b32 v247, 1
    s_nop 0
    v_cndmask_b32 v245, v232, v234, vcc
    s_lshl_b32 s63, s62, 18
    s_lshl_b32 s64, s61, 12
    s_add_u32 s64, s63, s64
    s_lshl_b32 s63, s60, 21
    s_add_u32 s63, s63, s64
    s_add_u32 s36, s18, s63
    s_addc_u32 s37, s19, 0
    s_mov_b32 s38, 0
    s_mov_b32 s39, 0x00020000
    s_sub_u32 s38, 1966080, s64
    s_mov_b32 s89, 131072
    s_mov_b32 s74, 0x41100000
    s_mov_b32 s90, 0x3e0293ee
    s_mov_b32 s91, s90
    s_cmp_eq_u32 s62, 7
    s_mov_b32 s88, 0xff800000
    s_cselect_b32 s88, 0x4f800000, s88
    v_lshrrev_b32 v232, 4, v1
    v_lshlrev_b32 v233, 10, v232
    v_bfe_u32 v234, v1, 2, 2
    v_lshl_add_u32 v233, v234, 6, v233
    v_and_b32 v234, 3, v1
    v_lshl_add_u32 v233, v234, 3, v233
    v_and_b32 v232, 1, v232
    v_lshl_add_u32 v233, v232, 5, v233
    v_add_u32 v6, 69632, v233
    v_xor_b32 v7, 32, v6
    s_movk_i32 s63, 1088
    v_lshrrev_b32 v235, 4, v1
    v_bfe_u32 v232, v1, 2, 2
    v_mul_u32_u24 v232, s63, v232
    v_and_b32 v233, 3, v1
    v_lshl_add_u32 v232, v233, 8, v232
    v_xor_b32 v234, v235, v233
    v_lshl_add_u32 v5, v234, 4, v232
    s_lshr_b32 s64, s2, 3
    s_and_b32 s94, s2, 6
    s_and_b32 s75, s2, 1
    s_and_b32 s63, s64, 1
    s_add_u32 s94, s94, s63
    s_bfe_u32 s92, s64, 0x10001
    s_lshr_b32 s93, s64, 2
    s_add_u32 s63, s64, 0
    s_and_b32 s63, s63, 3
    s_lshl_b32 s80, s63, 17
    s_add_u32 s63, s64, 1
    s_and_b32 s63, s63, 3
    s_lshl_b32 s81, s63, 17
    s_add_u32 s63, s64, 2
    s_and_b32 s63, s63, 3
    s_lshl_b32 s82, s63, 17
    s_add_u32 s63, s64, 3
    s_and_b32 s63, s63, 3
    s_lshl_b32 s83, s63, 17
    s_lshl_b32 s66, s75, 2
    s_add_u32 s66, s66, s101
    s_lshl_b32 s63, s66, 19
    s_lshl_b32 s64, s93, 7
    s_add_u32 s63, s63, s64
    s_and_b32 s64, s62, 4
    s_lshl_b32 s64, s64, 12
    s_add_u32 s63, s63, s64
    s_add_u32 s40, s12, s63
    s_addc_u32 s41, s13, 0
    s_sub_u32 s42, 4194304, s63
    s_mov_b32 s43, 0x00020000
    s_lshl_b32 s67, s92, 2
    s_and_b32 s64, s62, 4
    s_lshl_b32 s64, s64, 1
    s_add_u32 s67, s67, s64
    s_lshl_b32 s63, s67, 17
    s_lshl_b32 s64, s66, 14
    s_add_u32 s64, s63, s64
    s_lshl_b32 s63, s94, 21
    s_add_u32 s63, s63, s64
    s_add_u32 s52, s18, s63
    s_addc_u32 s53, s19, 0
    s_mov_b32 s54, 0
    s_mov_b32 s55, 0x00020000
    s_sub_u32 s54, 1966080, s64
    s_lshl_b32 s84, s75, 18
    s_xor_b32 s85, s84, 262144
    s_lshl_b32 s63, s94, 3
    s_add_u32 s63, s63, s66
    s_lshl_b32 s63, s63, 2
    s_lshr_b32 s64, s67, 2
    s_add_u32 s63, s63, s64
    s_lshl_b32 s63, s63, 7
    v_and_b32 v232, 7, v1
    v_lshlrev_b32 v233, 2, v232
    v_add_u32 v244, s63, v233
    v_lshl_add_u32 v250, v232, 5, 16
    s_lshr_b32 s63, s85, 17
    s_add_u32 s63, s63, s67
    s_bfe_u32 s64, s62, 0x10001
    s_add_u32 s63, s63, s64
    s_lshl_b32 s66, s63, 14
    s_mul_i32 s64, s94, 245760
    s_add_u32 s66, s66, s64
    s_lshl_b32 s64, s93, 7
    s_add_u32 s66, s66, s64
    s_and_b32 s64, s62, 1
    s_lshl_b32 s64, s64, 6
    s_add_u32 s66, s66, s64
    s_cmp_eq_u32 s63, 15
    s_cselect_b32 s66, 0x40000000, s66
    v_and_b32 v235, 15, v1
    v_lshlrev_b32 v235, 10, v235
    v_lshrrev_b32 v232, 4, v1
    v_lshl_add_u32 v235, v232, 3, v235
    v_add_u32 v246, s66, v235
    s_mov_b32 s44, s14
    s_mov_b32 s45, s15
    s_mov_b32 s46, 1966080
    s_mov_b32 s47, 0x00020000
    v_lshlrev_b32 v236, 4, v1
    v_lshrrev_b32 v232, 3, v1
    v_bfe_u32 v233, v1, 1, 2
    v_bfe_u32 v234, v1, 4, 2
    v_xor_b32 v233, v233, v234
    v_lshlrev_b32 v237, 10, v232
    v_lshl_add_u32 v237, v233, 5, v237
    v_and_b32 v232, 1, v1
    v_lshl_add_u32 v237, v232, 4, v237
    v_add_u32 v238, 8192, v237
    v_lshrrev_b32 v232, 2, v1
    v_lshlrev_b32 v232, 7, v232
    v_and_b32 v233, 3, v1
    v_lshl_add_u32 v232, v233, 3, v232
    v_bfe_u32 v233, v1, 3, 2
    v_lshl_add_u32 v232, v233, 5, v232
    s_lshl_b32 s63, s101, 11
    v_add_u32 v239, s63, v232
    v_xor_b32 v240, 32, v239
    v_xor_b32 v241, 64, v239
    v_xor_b32 v242, 96, v239
    s_add_u32 s63, s3, 1
    s_and_b32 s63, s63, 7
    s_lshl_b32 s64, s63, 19
    s_add_u32 s64, s64, s71
    s_lshl_b32 s63, s63, 7
    s_add_u32 s63, s63, s70
    s_add_u32 m0, s100, 137216
    s_add_u32 s72, s64, 0
    buffer_load_dwordx4 v12, s[32:35], s72 offen lds
    s_add_u32 m0, s100, 138240
    s_add_u32 s72, s64, 32768
    buffer_load_dwordx4 v12, s[32:35], s72 offen lds
    s_add_u32 m0, s100, 139264
    s_add_u32 s72, s64, 65536
    buffer_load_dwordx4 v13, s[32:35], s72 offen lds
    s_add_u32 m0, s100, 140288
    s_add_u32 s72, s64, 98304
    buffer_load_dwordx4 v13, s[32:35], s72 offen lds
    s_add_u32 m0, s69, 0
    s_add_u32 s73, s63, 0
    buffer_load_dwordx4 v14, s[20:23], s73 offen lds
    s_add_u32 m0, s69, 1088
    s_add_u32 s73, s63, 8192
    buffer_load_dwordx4 v14, s[20:23], s73 offen lds
    s_add_u32 m0, s69, 2176
    s_add_u32 s73, s63, 16384
    buffer_load_dwordx4 v14, s[20:23], s73 offen lds
    s_add_u32 m0, s69, 3264
    s_add_u32 s73, s63, 24576
    buffer_load_dwordx4 v14, s[20:23], s73 offen lds
    s_add_u32 m0, s69, 17408
    s_add_u32 s73, s63, 131072
    buffer_load_dwordx4 v14, s[20:23], s73 offen lds
    s_add_u32 m0, s69, 18496
    s_add_u32 s73, s63, 139264
    buffer_load_dwordx4 v14, s[20:23], s73 offen lds
    s_add_u32 m0, s69, 19584
    s_add_u32 s73, s63, 147456
    buffer_load_dwordx4 v14, s[20:23], s73 offen lds
    s_add_u32 m0, s69, 20672
    s_add_u32 s73, s63, 155648
    buffer_load_dwordx4 v14, s[20:23], s73 offen lds
    s_waitcnt vmcnt(13)
    s_barrier
    s_add_u32 s63, s3, 2
    s_and_b32 s63, s63, 7
    s_lshl_b32 s64, s63, 19
    s_add_u32 s64, s64, s71
    s_lshl_b32 s63, s63, 7
    s_add_u32 s63, s63, s70
    s_add_u32 m0, s100, 69632
    s_add_u32 s72, s64, 0
    buffer_load_dwordx4 v12, s[32:35], s72 offen lds
    s_add_u32 m0, s100, 70656
    s_add_u32 s72, s64, 32768
    buffer_load_dwordx4 v12, s[32:35], s72 offen lds
    s_add_u32 m0, s100, 71680
    s_add_u32 s72, s64, 65536
    buffer_load_dwordx4 v13, s[32:35], s72 offen lds
    s_add_u32 m0, s100, 72704
    s_add_u32 s72, s64, 98304
    buffer_load_dwordx4 v13, s[32:35], s72 offen lds
    s_add_u32 m0, s69, 34816
    s_add_u32 s73, s63, 0
    buffer_load_dwordx4 v14, s[20:23], s73 offen lds
    s_add_u32 m0, s69, 35904
    s_add_u32 s73, s63, 8192
    buffer_load_dwordx4 v14, s[20:23], s73 offen lds
    s_add_u32 m0, s69, 36992
    s_add_u32 s73, s63, 16384
    buffer_load_dwordx4 v14, s[20:23], s73 offen lds
    s_add_u32 m0, s69, 38080
    s_add_u32 s73, s63, 24576
    buffer_load_dwordx4 v14, s[20:23], s73 offen lds
    s_add_u32 m0, s69, 52224
    s_add_u32 s73, s63, 131072
    buffer_load_dwordx4 v14, s[20:23], s73 offen lds
    s_add_u32 m0, s69, 53312
    s_add_u32 s73, s63, 139264
    buffer_load_dwordx4 v14, s[20:23], s73 offen lds
    s_add_u32 m0, s69, 54400
    s_add_u32 s73, s63, 147456
    buffer_load_dwordx4 v14, s[20:23], s73 offen lds
    s_add_u32 m0, s69, 55488
    s_add_u32 s73, s63, 155648
    buffer_load_dwordx4 v14, s[20:23], s73 offen lds
    s_waitcnt vmcnt(12)
    s_barrier
    s_add_u32 s63, s3, 3
    s_and_b32 s63, s63, 7
    s_lshl_b32 s64, s63, 19
    s_add_u32 s64, s64, s71
    s_lshl_b32 s63, s63, 7
    s_add_u32 s63, s63, s70
    s_add_u32 m0, s100, 120832
    s_add_u32 s72, s64, 0
    buffer_load_dwordx4 v12, s[32:35], s72 offen lds
    s_add_u32 m0, s100, 121856
    s_add_u32 s72, s64, 32768
    buffer_load_dwordx4 v12, s[32:35], s72 offen lds
    s_add_u32 m0, s100, 122880
    s_add_u32 s72, s64, 65536
    buffer_load_dwordx4 v13, s[32:35], s72 offen lds
    s_add_u32 m0, s100, 123904
    s_add_u32 s72, s64, 98304
    buffer_load_dwordx4 v13, s[32:35], s72 offen lds
    s_add_u32 m0, s69, 86016
    s_add_u32 s73, s63, 0
    buffer_load_dwordx4 v14, s[20:23], s73 offen lds
    s_add_u32 m0, s69, 87104
    s_add_u32 s73, s63, 8192
    buffer_load_dwordx4 v14, s[20:23], s73 offen lds
    s_add_u32 m0, s69, 88192
    s_add_u32 s73, s63, 16384
    buffer_load_dwordx4 v14, s[20:23], s73 offen lds
    s_add_u32 m0, s69, 89280
    s_add_u32 s73, s63, 24576
    buffer_load_dwordx4 v14, s[20:23], s73 offen lds
    s_add_u32 m0, s69, 103424
    s_add_u32 s73, s63, 131072
    buffer_load_dwordx4 v14, s[20:23], s73 offen lds
    s_add_u32 m0, s69, 104512
    s_add_u32 s73, s63, 139264
    buffer_load_dwordx4 v14, s[20:23], s73 offen lds
    s_add_u32 m0, s69, 105600
    s_add_u32 s73, s63, 147456
    buffer_load_dwordx4 v14, s[20:23], s73 offen lds
    s_add_u32 m0, s69, 106688
    s_add_u32 s73, s63, 155648
    buffer_load_dwordx4 v14, s[20:23], s73 offen lds
    s_waitcnt vmcnt(12)
    s_barrier
    s_add_u32 s63, s3, 4
    s_and_b32 s63, s63, 7
    s_lshl_b32 s64, s63, 19
    s_add_u32 s64, s64, s71
    s_lshl_b32 s63, s63, 7
    s_add_u32 s63, s63, s70
    s_add_u32 m0, s100, 137216
    s_add_u32 s72, s64, 0
    buffer_load_dwordx4 v12, s[32:35], s72 offen lds
    s_add_u32 m0, s100, 138240
    s_add_u32 s72, s64, 32768
    buffer_load_dwordx4 v12, s[32:35], s72 offen lds
    s_add_u32 m0, s100, 139264
    s_add_u32 s72, s64, 65536
    buffer_load_dwordx4 v13, s[32:35], s72 offen lds
    s_add_u32 m0, s100, 140288
    s_add_u32 s72, s64, 98304
    buffer_load_dwordx4 v13, s[32:35], s72 offen lds
    s_add_u32 m0, s69, 0
    s_add_u32 s73, s63, 0
    buffer_load_dwordx4 v14, s[20:23], s73 offen lds
    s_add_u32 m0, s69, 1088
    s_add_u32 s73, s63, 8192
    buffer_load_dwordx4 v14, s[20:23], s73 offen lds
    s_add_u32 m0, s69, 2176
    s_add_u32 s73, s63, 16384
    buffer_load_dwordx4 v14, s[20:23], s73 offen lds
    s_add_u32 m0, s69, 3264
    s_add_u32 s73, s63, 24576
    buffer_load_dwordx4 v14, s[20:23], s73 offen lds
    s_add_u32 m0, s69, 17408
    s_add_u32 s73, s63, 131072
    buffer_load_dwordx4 v14, s[20:23], s73 offen lds
    s_add_u32 m0, s69, 18496
    s_add_u32 s73, s63, 139264
    buffer_load_dwordx4 v14, s[20:23], s73 offen lds
    s_add_u32 m0, s69, 19584
    s_add_u32 s73, s63, 147456
    buffer_load_dwordx4 v14, s[20:23], s73 offen lds
    s_add_u32 m0, s69, 20672
    s_add_u32 s73, s63, 155648
    buffer_load_dwordx4 v14, s[20:23], s73 offen lds
    s_waitcnt vmcnt(12)
    s_barrier
    s_add_u32 s63, s3, 5
    s_and_b32 s63, s63, 7
    s_lshl_b32 s64, s63, 19
    s_add_u32 s64, s64, s71
    s_lshl_b32 s63, s63, 7
    s_add_u32 s63, s63, s70
    s_add_u32 m0, s100, 69632
    s_add_u32 s72, s64, 0
    buffer_load_dwordx4 v12, s[32:35], s72 offen lds
    s_add_u32 m0, s100, 70656
    s_add_u32 s72, s64, 32768
    buffer_load_dwordx4 v12, s[32:35], s72 offen lds
    s_add_u32 m0, s100, 71680
    s_add_u32 s72, s64, 65536
    buffer_load_dwordx4 v13, s[32:35], s72 offen lds
    s_add_u32 m0, s100, 72704
    s_add_u32 s72, s64, 98304
    buffer_load_dwordx4 v13, s[32:35], s72 offen lds
    s_add_u32 m0, s69, 34816
    s_add_u32 s73, s63, 0
    buffer_load_dwordx4 v14, s[20:23], s73 offen lds
    s_add_u32 m0, s69, 35904
    s_add_u32 s73, s63, 8192
    buffer_load_dwordx4 v14, s[20:23], s73 offen lds
    s_add_u32 m0, s69, 36992
    s_add_u32 s73, s63, 16384
    buffer_load_dwordx4 v14, s[20:23], s73 offen lds
    s_add_u32 m0, s69, 38080
    s_add_u32 s73, s63, 24576
    buffer_load_dwordx4 v14, s[20:23], s73 offen lds
    s_add_u32 m0, s69, 52224
    s_add_u32 s73, s63, 131072
    buffer_load_dwordx4 v14, s[20:23], s73 offen lds
    s_add_u32 m0, s69, 53312
    s_add_u32 s73, s63, 139264
    buffer_load_dwordx4 v14, s[20:23], s73 offen lds
    s_add_u32 m0, s69, 54400
    s_add_u32 s73, s63, 147456
    buffer_load_dwordx4 v14, s[20:23], s73 offen lds
    s_add_u32 m0, s69, 55488
    s_add_u32 s73, s63, 155648
    buffer_load_dwordx4 v14, s[20:23], s73 offen lds
    s_waitcnt vmcnt(12)
    s_barrier
    s_add_u32 s63, s3, 6
    s_and_b32 s63, s63, 7
    s_lshl_b32 s64, s63, 19
    s_add_u32 s64, s64, s71
    s_lshl_b32 s63, s63, 7
    s_add_u32 s63, s63, s70
    s_add_u32 m0, s100, 120832
    s_add_u32 s72, s64, 0
    buffer_load_dwordx4 v12, s[32:35], s72 offen lds
    s_add_u32 m0, s100, 121856
    s_add_u32 s72, s64, 32768
    buffer_load_dwordx4 v12, s[32:35], s72 offen lds
    s_add_u32 m0, s100, 122880
    s_add_u32 s72, s64, 65536
    buffer_load_dwordx4 v13, s[32:35], s72 offen lds
    s_add_u32 m0, s100, 123904
    s_add_u32 s72, s64, 98304
    buffer_load_dwordx4 v13, s[32:35], s72 offen lds
    s_add_u32 m0, s69, 86016
    s_add_u32 s73, s63, 0
    buffer_load_dwordx4 v14, s[20:23], s73 offen lds
    s_add_u32 m0, s69, 87104
    s_add_u32 s73, s63, 8192
    buffer_load_dwordx4 v14, s[20:23], s73 offen lds
    s_add_u32 m0, s69, 88192
    s_add_u32 s73, s63, 16384
    buffer_load_dwordx4 v14, s[20:23], s73 offen lds
    s_add_u32 m0, s69, 89280
    s_add_u32 s73, s63, 24576
    buffer_load_dwordx4 v14, s[20:23], s73 offen lds
    s_add_u32 m0, s69, 103424
    s_add_u32 s73, s63, 131072
    buffer_load_dwordx4 v14, s[20:23], s73 offen lds
    s_add_u32 m0, s69, 104512
    s_add_u32 s73, s63, 139264
    buffer_load_dwordx4 v14, s[20:23], s73 offen lds
    s_add_u32 m0, s69, 105600
    s_add_u32 s73, s63, 147456
    buffer_load_dwordx4 v14, s[20:23], s73 offen lds
    s_add_u32 m0, s69, 106688
    s_add_u32 s73, s63, 155648
    buffer_load_dwordx4 v14, s[20:23], s73 offen lds
    s_waitcnt vmcnt(12)
    s_barrier
    s_add_u32 s63, s3, 7
    s_and_b32 s63, s63, 7
    s_lshl_b32 s64, s63, 19
    s_add_u32 s64, s64, s71
    s_lshl_b32 s63, s63, 7
    s_add_u32 s63, s63, s70
    s_add_u32 m0, s100, 137216
    s_add_u32 s72, s64, 0
    buffer_load_dwordx4 v12, s[32:35], s72 offen lds
    s_add_u32 m0, s100, 138240
    s_add_u32 s72, s64, 32768
    buffer_load_dwordx4 v12, s[32:35], s72 offen lds
    s_add_u32 m0, s100, 139264
    s_add_u32 s72, s64, 65536
    buffer_load_dwordx4 v13, s[32:35], s72 offen lds
    s_add_u32 m0, s100, 140288
    s_add_u32 s72, s64, 98304
    buffer_load_dwordx4 v13, s[32:35], s72 offen lds
    s_add_u32 m0, s69, 0
    s_add_u32 s73, s63, 0
    buffer_load_dwordx4 v14, s[20:23], s73 offen lds
    s_add_u32 m0, s69, 1088
    s_add_u32 s73, s63, 8192
    buffer_load_dwordx4 v14, s[20:23], s73 offen lds
    s_add_u32 m0, s69, 2176
    s_add_u32 s73, s63, 16384
    buffer_load_dwordx4 v14, s[20:23], s73 offen lds
    s_add_u32 m0, s69, 3264
    s_add_u32 s73, s63, 24576
    buffer_load_dwordx4 v14, s[20:23], s73 offen lds
    s_add_u32 m0, s69, 17408
    s_add_u32 s73, s63, 131072
    buffer_load_dwordx4 v14, s[20:23], s73 offen lds
    s_add_u32 m0, s69, 18496
    s_add_u32 s73, s63, 139264
    buffer_load_dwordx4 v14, s[20:23], s73 offen lds
    s_add_u32 m0, s69, 19584
    s_add_u32 s73, s63, 147456
    buffer_load_dwordx4 v14, s[20:23], s73 offen lds
    s_add_u32 m0, s69, 20672
    s_add_u32 s73, s63, 155648
    buffer_load_dwordx4 v14, s[20:23], s73 offen lds
    s_waitcnt vmcnt(12)
    s_barrier
    s_add_u32 m0, s69, 52224
    s_add_u32 s73, s100, 0
    buffer_load_dwordx4 v2, s[24:27], s73 offen offset:0 nt lds
    s_add_u32 m0, s69, 52288
    s_add_u32 s73, s100, 0
    buffer_load_dwordx4 v2, s[24:27], s73 offen offset:1024 nt lds
    s_add_u32 m0, s69, 52352
    s_add_u32 s73, s100, 0
    buffer_load_dwordx4 v2, s[24:27], s73 offen offset:2048 nt lds
    s_add_u32 m0, s69, 52416
    s_add_u32 s73, s100, 0
    buffer_load_dwordx4 v2, s[24:27], s73 offen offset:3072 nt lds
    s_add_u32 m0, s69, 34816
    s_add_u32 s73, s100, 16384
    buffer_load_dwordx4 v2, s[24:27], s73 offen offset:0 nt lds
    s_add_u32 m0, s69, 34880
    s_add_u32 s73, s100, 16384
    buffer_load_dwordx4 v2, s[24:27], s73 offen offset:1024 nt lds
    s_add_u32 m0, s69, 34944
    s_add_u32 s73, s100, 16384
    buffer_load_dwordx4 v2, s[24:27], s73 offen offset:2048 nt lds
    s_add_u32 m0, s69, 35008
    s_add_u32 s73, s100, 16384
    buffer_load_dwordx4 v2, s[24:27], s73 offen offset:3072 nt lds
    s_waitcnt vmcnt(8)
    s_barrier
    s_add_u32 m0, s100, 69632
    s_add_u32 s73, s100, 0
    buffer_load_dwordx4 v3, s[28:31], s73 offen offset:0 nt lds
    s_add_u32 m0, s100, 69632
    s_add_u32 s73, s100, 0
    buffer_load_dwordx4 v4, s[28:31], s73 offen offset:1024 nt lds
    s_add_u32 m0, s100, 69632
    s_add_u32 s73, s100, 0
    buffer_load_dwordx4 v3, s[28:31], s73 offen offset:2048 nt lds
    s_add_u32 m0, s100, 69632
    s_add_u32 s73, s100, 0
    buffer_load_dwordx4 v4, s[28:31], s73 offen offset:3072 nt lds
    s_add_u32 m0, s100, 86016
    s_add_u32 s73, s100, 16384
    buffer_load_dwordx4 v3, s[28:31], s73 offen offset:0 nt lds
    s_add_u32 m0, s100, 86016
    s_add_u32 s73, s100, 16384
    buffer_load_dwordx4 v4, s[28:31], s73 offen offset:1024 nt lds
    s_add_u32 m0, s100, 86016
    s_add_u32 s73, s100, 16384
    buffer_load_dwordx4 v3, s[28:31], s73 offen offset:2048 nt lds
    s_add_u32 m0, s100, 86016
    s_add_u32 s73, s100, 16384
    buffer_load_dwordx4 v4, s[28:31], s73 offen offset:3072 nt lds
    v_add_u32 v232, s69, v236
    v_add_u32 v233, 103424, v232
    s_waitcnt vmcnt(12)
    s_barrier
    ds_read_b128 v[80:83], v233 offset:0
    ds_read_b128 v[84:87], v233 offset:1024
    ds_read_b128 v[88:91], v233 offset:2048
    ds_read_b128 v[92:95], v233 offset:3072
    ds_read_b128 v[96:99], v232 offset:17408
    ds_read_b128 v[100:103], v232 offset:18432
    ds_read_b128 v[104:107], v232 offset:19456
    ds_read_b128 v[108:111], v232 offset:20480
    s_waitcnt lgkmcnt(0)
    s_branch L_attn
L_compute:
    v_lshrrev_b32 v232, 4, v1
    v_lshlrev_b32 v233, 11, v232
    v_bfe_u32 v234, v1, 2, 2
    v_lshl_add_u32 v233, v234, 6, v233
    v_and_b32 v234, 3, v1
    v_lshl_add_u32 v233, v234, 3, v233
    v_and_b32 v232, 1, v232
    v_lshl_add_u32 v233, v232, 5, v233
    v_add_u32 v12, 120832, v233
    v_xor_b32 v13, 32, v12
    s_movk_i32 s63, 1088
    v_lshrrev_b32 v235, 4, v1
    v_bfe_u32 v232, v1, 3, 1
    v_mul_u32_u24 v232, s63, v232
    v_and_b32 v233, 7, v1
    v_lshl_add_u32 v232, v233, 7, v232
    s_add_u32 s64, s69, 86016
    v_add_u32 v232, s64, v232
    v_bfe_u32 v233, v1, 1, 2
    v_xor_b32 v234, v235, v233
    v_lshl_add_u32 v14, v234, 4, v232
    s_waitcnt lgkmcnt(0)
    s_lshl_b32 s63, s60, 5
    s_add_u32 s63, s63, s61
    s_lshl_b32 s63, s63, 17
    s_add_u32 s24, s6, s63
    s_addc_u32 s25, s7, 0
    s_mov_b32 s26, 131072
    s_mov_b32 s27, 0x00020000
    s_add_u32 s28, s8, s63
    s_addc_u32 s29, s9, 0
    s_mov_b32 s30, 131072
    s_mov_b32 s31, 0x00020000
    v_bfe_u32 v232, v1, 2, 2
    v_lshrrev_b32 v233, 4, v1
    v_and_b32 v234, 3, v1
    v_lshlrev_b32 v234, 4, v234
    v_lshl_add_u32 v234, v233, 6, v234
    v_lshl_add_u32 v3, v232, 8, v234
    v_xor_b32 v4, 32, v3
    v_and_b32 v234, 15, v1
    v_xor_b32 v234, v234, v233
    v_lshlrev_b32 v234, 4, v234
    v_lshl_add_u32 v2, v233, 8, v234
    s_mul_i32 s65, s62, 2176
    s_lshl_b32 s68, s62, 11
    s_mov_b32 s63, 16777216
    s_add_u32 s56, s18, s63
    s_addc_u32 s57, s19, 0
    s_mov_b32 s58, 32768
    s_mov_b32 s59, 0x00020000
    s_mov_b32 s48, s16
    s_mov_b32 s49, s17
    s_mov_b32 s50, 256
    s_mov_b32 s51, 0x00020000
    s_lshl_b32 s63, s60, 3
    s_lshr_b32 s64, s61, 2
    s_add_u32 s63, s63, s64
    s_lshl_b32 s63, s63, 2
    s_lshr_b32 s64, s62, 1
    s_add_u32 s63, s63, s64
    s_lshl_b32 s63, s63, 7
    s_and_b32 s64, s61, 3
    s_lshl_b32 s64, s64, 3
    s_add_u32 s63, s63, s64
    s_and_b32 s64, s62, 1
    s_lshl_b32 s64, s64, 2
    s_add_u32 s63, s63, s64
    v_mov_b32 v232, 0x7ffffff0
    v_mov_b32 v233, s63
    v_cmp_eq_u32 vcc, 0, v1
    v_mov_b32 v8, 0
    v_mov_b32 v9, 0
    s_lshl_b32 s64, s60, 5
    s_add_u32 s64, s64, 16
    v_mov_b32 v234, s64
    v_cndmask_b32 v243, v232, v233, vcc
    buffer_store_dword v8, v243, s[56:59], 0 offen sc1
    v_cmp_eq_u32 vcc, 0, v0
    v_mov_b32 v247, 1
    s_nop 0
    v_cndmask_b32 v245, v232, v234, vcc
    s_lshl_b32 s63, s62, 18
    s_lshl_b32 s64, s61, 12
    s_add_u32 s64, s63, s64
    s_lshl_b32 s63, s60, 21
    s_add_u32 s63, s63, s64
    s_add_u32 s36, s18, s63
    s_addc_u32 s37, s19, 0
    s_mov_b32 s38, 0
    s_mov_b32 s39, 0x00020000
    s_sub_u32 s38, 1966080, s64
    s_mov_b32 s89, 131072
    s_mov_b32 s74, 0x41100000
    s_mov_b32 s90, 0x3e0293ee
    s_mov_b32 s91, s90
    s_cmp_eq_u32 s62, 7
    s_mov_b32 s88, 0xff800000
    s_cselect_b32 s88, 0x4f800000, s88
    v_lshrrev_b32 v232, 4, v1
    v_lshlrev_b32 v233, 10, v232
    v_bfe_u32 v234, v1, 2, 2
    v_lshl_add_u32 v233, v234, 6, v233
    v_and_b32 v234, 3, v1
    v_lshl_add_u32 v233, v234, 3, v233
    v_and_b32 v232, 1, v232
    v_lshl_add_u32 v233, v232, 5, v233
    v_add_u32 v6, 69632, v233
    v_xor_b32 v7, 32, v6
    s_movk_i32 s63, 1088
    v_lshrrev_b32 v235, 4, v1
    v_bfe_u32 v232, v1, 2, 2
    v_mul_u32_u24 v232, s63, v232
    v_and_b32 v233, 3, v1
    v_lshl_add_u32 v232, v233, 8, v232
    v_xor_b32 v234, v235, v233
    v_lshl_add_u32 v5, v234, 4, v232
    s_lshr_b32 s64, s2, 3
    s_and_b32 s94, s2, 6
    s_and_b32 s75, s2, 1
    s_and_b32 s63, s64, 1
    s_add_u32 s94, s94, s63
    s_bfe_u32 s92, s64, 0x10001
    s_lshr_b32 s93, s64, 2
    s_add_u32 s63, s64, 0
    s_and_b32 s63, s63, 3
    s_lshl_b32 s80, s63, 17
    s_add_u32 s63, s64, 1
    s_and_b32 s63, s63, 3
    s_lshl_b32 s81, s63, 17
    s_add_u32 s63, s64, 2
    s_and_b32 s63, s63, 3
    s_lshl_b32 s82, s63, 17
    s_add_u32 s63, s64, 3
    s_and_b32 s63, s63, 3
    s_lshl_b32 s83, s63, 17
    s_lshl_b32 s66, s75, 2
    s_add_u32 s66, s66, s101
    s_lshl_b32 s63, s66, 19
    s_lshl_b32 s64, s93, 7
    s_add_u32 s63, s63, s64
    s_and_b32 s64, s62, 4
    s_lshl_b32 s64, s64, 12
    s_add_u32 s63, s63, s64
    s_add_u32 s40, s12, s63
    s_addc_u32 s41, s13, 0
    s_sub_u32 s42, 4194304, s63
    s_mov_b32 s43, 0x00020000
    s_lshl_b32 s67, s92, 2
    s_and_b32 s64, s62, 4
    s_lshl_b32 s64, s64, 1
    s_add_u32 s67, s67, s64
    s_lshl_b32 s63, s67, 17
    s_lshl_b32 s64, s66, 14
    s_add_u32 s64, s63, s64
    s_lshl_b32 s63, s94, 21
    s_add_u32 s63, s63, s64
    s_add_u32 s52, s18, s63
    s_addc_u32 s53, s19, 0
    s_mov_b32 s54, 0
    s_mov_b32 s55, 0x00020000
    s_sub_u32 s54, 1966080, s64
    s_lshl_b32 s84, s75, 18
    s_xor_b32 s85, s84, 262144
    s_lshl_b32 s63, s94, 3
    s_add_u32 s63, s63, s66
    s_lshl_b32 s63, s63, 2
    s_lshr_b32 s64, s67, 2
    s_add_u32 s63, s63, s64
    s_lshl_b32 s63, s63, 7
    v_and_b32 v232, 7, v1
    v_lshlrev_b32 v233, 2, v232
    v_add_u32 v244, s63, v233
    v_lshl_add_u32 v250, v232, 5, 16
    s_lshr_b32 s63, s85, 17
    s_add_u32 s63, s63, s67
    s_bfe_u32 s64, s62, 0x10001
    s_add_u32 s63, s63, s64
    s_lshl_b32 s66, s63, 14
    s_mul_i32 s64, s94, 245760
    s_add_u32 s66, s66, s64
    s_lshl_b32 s64, s93, 7
    s_add_u32 s66, s66, s64
    s_and_b32 s64, s62, 1
    s_lshl_b32 s64, s64, 6
    s_add_u32 s66, s66, s64
    s_cmp_eq_u32 s63, 15
    s_cselect_b32 s66, 0x40000000, s66
    v_and_b32 v235, 15, v1
    v_lshlrev_b32 v235, 10, v235
    v_lshrrev_b32 v232, 4, v1
    v_lshl_add_u32 v235, v232, 3, v235
    v_add_u32 v246, s66, v235
    s_mov_b32 s44, s14
    s_mov_b32 s45, s15
    s_mov_b32 s46, 1966080
    s_mov_b32 s47, 0x00020000
    v_lshlrev_b32 v236, 4, v1
    v_lshrrev_b32 v232, 3, v1
    v_bfe_u32 v233, v1, 1, 2
    v_bfe_u32 v234, v1, 4, 2
    v_xor_b32 v233, v233, v234
    v_lshlrev_b32 v237, 10, v232
    v_lshl_add_u32 v237, v233, 5, v237
    v_and_b32 v232, 1, v1
    v_lshl_add_u32 v237, v232, 4, v237
    v_add_u32 v238, 8192, v237
    v_lshrrev_b32 v232, 2, v1
    v_lshlrev_b32 v232, 7, v232
    v_and_b32 v233, 3, v1
    v_lshl_add_u32 v232, v233, 3, v232
    v_bfe_u32 v233, v1, 3, 2
    v_lshl_add_u32 v232, v233, 5, v232
    s_lshl_b32 s63, s101, 11
    v_add_u32 v239, s63, v232
    v_xor_b32 v240, 32, v239
    v_xor_b32 v241, 64, v239
    v_xor_b32 v242, 96, v239
    s_getpc_b64 s[20:21]
L_pc:
    s_mov_b32 s22, L_code_end-L_pc
    s_mov_b32 s23, 0x00020000
    s_lshl_b32 s63, s101, 13
    s_add_u32 s64, s63, 32768
    v_lshlrev_b32 v232, 7, v1
    buffer_load_dword v234, v232, s[20:23], s63 offen
    buffer_load_dword v235, v232, s[20:23], s64 offen
    v_and_b32 v232, 15, v1
    v_lshlrev_b32 v232, 4, v232
    v_lshrrev_b32 v233, 5, v1
    v_lshl_add_u32 v232, v233, 8, v232
    v_bfe_u32 v233, v1, 4, 1
    v_lshl_add_u32 v232, v233, 3, v232
    v_add_u32 v213, s69, v232
    v_add_u32 v212, 103424, v213
    s_barrier
    ds_read_b128 v[160:163], v14 offset:17408
    ds_read_b128 v[164:167], v14 offset:19584
    ds_read_b128 v[144:147], v14 offset:0
    ds_read_b128 v[148:151], v14 offset:2176
    ds_read_b64_tr_b16 v[176:177], v12 offset:0
    ds_read_b64_tr_b16 v[178:179], v12 offset:1024
    ds_read_b64_tr_b16 v[180:181], v13 offset:0
    ds_read_b64_tr_b16 v[182:183], v13 offset:1024
    ds_read_b64_tr_b16 v[184:185], v12 offset:256
    ds_read_b64_tr_b16 v[186:187], v12 offset:1280
    ds_read_b64_tr_b16 v[188:189], v13 offset:256
    ds_read_b64_tr_b16 v[190:191], v13 offset:1280
    s_waitcnt lgkmcnt(6)
    v_mfma_f32_16x16x32_bf16 v[80:83], v[176:179], v[160:163], 0
    v_mfma_f32_16x16x32_bf16 v[84:87], v[176:179], v[164:167], 0
    v_mfma_f32_16x16x32_bf16 v[16:19], v[176:179], v[144:147], 0
    v_mfma_f32_16x16x32_bf16 v[20:23], v[176:179], v[148:151], 0
    s_waitcnt lgkmcnt(4)
    ds_read_b64_tr_b16 v[192:193], v12 offset:512
    v_mfma_f32_16x16x32_bf16 v[88:91], v[180:183], v[160:163], 0
    ds_read_b64_tr_b16 v[194:195], v12 offset:1536
    v_mfma_f32_16x16x32_bf16 v[92:95], v[180:183], v[164:167], 0
    v_mfma_f32_16x16x32_bf16 v[24:27], v[180:183], v[144:147], 0
    v_mfma_f32_16x16x32_bf16 v[28:31], v[180:183], v[148:151], 0
    s_waitcnt lgkmcnt(4)
    ds_read_b64_tr_b16 v[196:197], v13 offset:512
    ds_read_b64_tr_b16 v[198:199], v13 offset:1536
    v_mfma_f32_16x16x32_bf16 v[96:99], v[184:187], v[160:163], 0
    ds_read_b128 v[168:171], v14 offset:17472
    v_mfma_f32_16x16x32_bf16 v[100:103], v[184:187], v[164:167], 0
    ds_read_b128 v[172:175], v14 offset:19648
    v_mfma_f32_16x16x32_bf16 v[32:35], v[184:187], v[144:147], 0
    v_mfma_f32_16x16x32_bf16 v[36:39], v[184:187], v[148:151], 0
    s_waitcnt lgkmcnt(6)
    ds_read_b64_tr_b16 v[200:201], v12 offset:768
    ds_read_b64_tr_b16 v[202:203], v12 offset:1792
    v_mfma_f32_16x16x32_bf16 v[104:107], v[188:191], v[160:163], 0
    ds_read_b128 v[152:155], v14 offset:64
    v_mfma_f32_16x16x32_bf16 v[108:111], v[188:191], v[164:167], 0
    ds_read_b128 v[156:159], v14 offset:2240
    v_mfma_f32_16x16x32_bf16 v[40:43], v[188:191], v[144:147], 0
    v_mfma_f32_16x16x32_bf16 v[44:47], v[188:191], v[148:151], 0
    s_waitcnt lgkmcnt(8)
    ds_read_b64_tr_b16 v[204:205], v13 offset:768
    v_mfma_f32_16x16x32_bf16 v[112:115], v[192:195], v[160:163], 0
    ds_read_b64_tr_b16 v[206:207], v13 offset:1792
    v_mfma_f32_16x16x32_bf16 v[116:119], v[192:195], v[164:167], 0
    v_mfma_f32_16x16x32_bf16 v[48:51], v[192:195], v[144:147], 0
    v_mfma_f32_16x16x32_bf16 v[52:55], v[192:195], v[148:151], 0
    s_waitcnt lgkmcnt(8)
    ds_read_b64_tr_b16 v[208:209], v12 offset:8192
    v_mfma_f32_16x16x32_bf16 v[120:123], v[196:199], v[160:163], 0
    ds_read_b64_tr_b16 v[210:211], v12 offset:9216
    v_mfma_f32_16x16x32_bf16 v[124:127], v[196:199], v[164:167], 0
    v_mfma_f32_16x16x32_bf16 v[56:59], v[196:199], v[144:147], 0
    v_mfma_f32_16x16x32_bf16 v[60:63], v[196:199], v[148:151], 0
    s_waitcnt lgkmcnt(6)
    ds_read_b64_tr_b16 v[176:177], v13 offset:8192
    v_mfma_f32_16x16x32_bf16 v[128:131], v[200:203], v[160:163], 0
    ds_read_b64_tr_b16 v[178:179], v13 offset:9216
    v_mfma_f32_16x16x32_bf16 v[132:135], v[200:203], v[164:167], 0
    v_mfma_f32_16x16x32_bf16 v[64:67], v[200:203], v[144:147], 0
    v_mfma_f32_16x16x32_bf16 v[68:71], v[200:203], v[148:151], 0
    s_waitcnt lgkmcnt(4)
    ds_read_b64_tr_b16 v[180:181], v12 offset:8448
    v_mfma_f32_16x16x32_bf16 v[136:139], v[204:207], v[160:163], 0
    ds_read_b64_tr_b16 v[182:183], v12 offset:9472
    v_mfma_f32_16x16x32_bf16 v[140:143], v[204:207], v[164:167], 0
    v_mfma_f32_16x16x32_bf16 v[72:75], v[204:207], v[144:147], 0
    v_mfma_f32_16x16x32_bf16 v[76:79], v[204:207], v[148:151], 0
    s_waitcnt lgkmcnt(4)
    ds_read_b64_tr_b16 v[184:185], v13 offset:8448
    v_mfma_f32_16x16x32_bf16 v[80:83], v[208:211], v[168:171], v[80:83]
    ds_read_b64_tr_b16 v[186:187], v13 offset:9472
    v_mfma_f32_16x16x32_bf16 v[84:87], v[208:211], v[172:175], v[84:87]
    v_mfma_f32_16x16x32_bf16 v[16:19], v[208:211], v[152:155], v[16:19]
    v_mfma_f32_16x16x32_bf16 v[20:23], v[208:211], v[156:159], v[20:23]
    s_waitcnt lgkmcnt(4)
    ds_read_b64_tr_b16 v[188:189], v12 offset:8704
    v_mfma_f32_16x16x32_bf16 v[88:91], v[176:179], v[168:171], v[88:91]
    ds_read_b64_tr_b16 v[190:191], v12 offset:9728
    v_mfma_f32_16x16x32_bf16 v[92:95], v[176:179], v[172:175], v[92:95]
    v_mfma_f32_16x16x32_bf16 v[24:27], v[176:179], v[152:155], v[24:27]
    v_mfma_f32_16x16x32_bf16 v[28:31], v[176:179], v[156:159], v[28:31]
    s_waitcnt lgkmcnt(4)
    ds_read_b64_tr_b16 v[192:193], v13 offset:8704
    v_mfma_f32_16x16x32_bf16 v[96:99], v[180:183], v[168:171], v[96:99]
    ds_read_b64_tr_b16 v[194:195], v13 offset:9728
    v_mfma_f32_16x16x32_bf16 v[100:103], v[180:183], v[172:175], v[100:103]
    v_mfma_f32_16x16x32_bf16 v[32:35], v[180:183], v[152:155], v[32:35]
    v_mfma_f32_16x16x32_bf16 v[36:39], v[180:183], v[156:159], v[36:39]
    s_waitcnt lgkmcnt(4)
    ds_read_b64_tr_b16 v[196:197], v12 offset:8960
    v_mfma_f32_16x16x32_bf16 v[104:107], v[184:187], v[168:171], v[104:107]
    ds_read_b64_tr_b16 v[198:199], v12 offset:9984
    v_mfma_f32_16x16x32_bf16 v[108:111], v[184:187], v[172:175], v[108:111]
    v_mfma_f32_16x16x32_bf16 v[40:43], v[184:187], v[152:155], v[40:43]
    v_mfma_f32_16x16x32_bf16 v[44:47], v[184:187], v[156:159], v[44:47]
    s_waitcnt lgkmcnt(4)
    ds_read_b64_tr_b16 v[200:201], v13 offset:8960
    v_mfma_f32_16x16x32_bf16 v[112:115], v[188:191], v[168:171], v[112:115]
    ds_read_b64_tr_b16 v[202:203], v13 offset:9984
    v_mfma_f32_16x16x32_bf16 v[116:119], v[188:191], v[172:175], v[116:119]
    v_mfma_f32_16x16x32_bf16 v[48:51], v[188:191], v[152:155], v[48:51]
    v_mfma_f32_16x16x32_bf16 v[52:55], v[188:191], v[156:159], v[52:55]
    s_waitcnt lgkmcnt(4)
    v_mfma_f32_16x16x32_bf16 v[120:123], v[192:195], v[168:171], v[120:123]
    v_mfma_f32_16x16x32_bf16 v[124:127], v[192:195], v[172:175], v[124:127]
    v_mfma_f32_16x16x32_bf16 v[56:59], v[192:195], v[152:155], v[56:59]
    v_mfma_f32_16x16x32_bf16 v[60:63], v[192:195], v[156:159], v[60:63]
    s_waitcnt lgkmcnt(2)
    s_waitcnt lgkmcnt(0)
    s_barrier
    v_add_u32 v14, 0xfffeb000, v14
    v_add_u32 v12, 0x4000, v12
    v_add_u32 v13, 0x4000, v13
    ds_read_b128 v[160:163], v14 offset:17408
    ds_read_b128 v[164:167], v14 offset:19584
    v_mfma_f32_16x16x32_bf16 v[128:131], v[196:199], v[168:171], v[128:131]
    ds_read_b128 v[144:147], v14 offset:0
    ds_read_b128 v[148:151], v14 offset:2176
    v_mfma_f32_16x16x32_bf16 v[132:135], v[196:199], v[172:175], v[132:135]
    ds_read_b64_tr_b16 v[204:205], v12 offset:0
    ds_read_b64_tr_b16 v[206:207], v12 offset:1024
    v_mfma_f32_16x16x32_bf16 v[64:67], v[196:199], v[152:155], v[64:67]
    ds_read_b64_tr_b16 v[208:209], v13 offset:0
    v_mfma_f32_16x16x32_bf16 v[68:71], v[196:199], v[156:159], v[68:71]
    ds_read_b64_tr_b16 v[210:211], v13 offset:1024
    ds_read_b64_tr_b16 v[176:177], v12 offset:256
    v_mfma_f32_16x16x32_bf16 v[136:139], v[200:203], v[168:171], v[136:139]
    ds_read_b64_tr_b16 v[178:179], v12 offset:1280
    v_mfma_f32_16x16x32_bf16 v[140:143], v[200:203], v[172:175], v[140:143]
    v_mfma_f32_16x16x32_bf16 v[72:75], v[200:203], v[152:155], v[72:75]
    v_mfma_f32_16x16x32_bf16 v[76:79], v[200:203], v[156:159], v[76:79]
    s_waitcnt lgkmcnt(4)
    ds_read_b64_tr_b16 v[180:181], v13 offset:256
    v_mfma_f32_16x16x32_bf16 v[80:83], v[204:207], v[160:163], v[80:83]
    ds_read_b64_tr_b16 v[182:183], v13 offset:1280
    v_mfma_f32_16x16x32_bf16 v[84:87], v[204:207], v[164:167], v[84:87]
    v_mfma_f32_16x16x32_bf16 v[16:19], v[204:207], v[144:147], v[16:19]
    v_mfma_f32_16x16x32_bf16 v[20:23], v[204:207], v[148:151], v[20:23]
    s_waitcnt lgkmcnt(4)
    ds_read_b64_tr_b16 v[184:185], v12 offset:512
    v_mfma_f32_16x16x32_bf16 v[88:91], v[208:211], v[160:163], v[88:91]
    ds_read_b64_tr_b16 v[186:187], v12 offset:1536
    v_mfma_f32_16x16x32_bf16 v[92:95], v[208:211], v[164:167], v[92:95]
    v_mfma_f32_16x16x32_bf16 v[24:27], v[208:211], v[144:147], v[24:27]
    v_mfma_f32_16x16x32_bf16 v[28:31], v[208:211], v[148:151], v[28:31]
    s_waitcnt lgkmcnt(4)
    ds_read_b64_tr_b16 v[188:189], v13 offset:512
    ds_read_b64_tr_b16 v[190:191], v13 offset:1536
    v_mfma_f32_16x16x32_bf16 v[96:99], v[176:179], v[160:163], v[96:99]
    ds_read_b128 v[168:171], v14 offset:17472
    v_mfma_f32_16x16x32_bf16 v[100:103], v[176:179], v[164:167], v[100:103]
    ds_read_b128 v[172:175], v14 offset:19648
    v_mfma_f32_16x16x32_bf16 v[32:35], v[176:179], v[144:147], v[32:35]
    v_mfma_f32_16x16x32_bf16 v[36:39], v[176:179], v[148:151], v[36:39]
    s_waitcnt lgkmcnt(6)
    ds_read_b64_tr_b16 v[192:193], v12 offset:768
    ds_read_b64_tr_b16 v[194:195], v12 offset:1792
    v_mfma_f32_16x16x32_bf16 v[104:107], v[180:183], v[160:163], v[104:107]
    ds_read_b128 v[152:155], v14 offset:64
    v_mfma_f32_16x16x32_bf16 v[108:111], v[180:183], v[164:167], v[108:111]
    ds_read_b128 v[156:159], v14 offset:2240
    v_mfma_f32_16x16x32_bf16 v[40:43], v[180:183], v[144:147], v[40:43]
    v_mfma_f32_16x16x32_bf16 v[44:47], v[180:183], v[148:151], v[44:47]
    s_waitcnt lgkmcnt(8)
    ds_read_b64_tr_b16 v[196:197], v13 offset:768
    v_mfma_f32_16x16x32_bf16 v[112:115], v[184:187], v[160:163], v[112:115]
    ds_read_b64_tr_b16 v[198:199], v13 offset:1792
    v_mfma_f32_16x16x32_bf16 v[116:119], v[184:187], v[164:167], v[116:119]
    v_mfma_f32_16x16x32_bf16 v[48:51], v[184:187], v[144:147], v[48:51]
    v_mfma_f32_16x16x32_bf16 v[52:55], v[184:187], v[148:151], v[52:55]
    s_waitcnt lgkmcnt(8)
    ds_read_b64_tr_b16 v[200:201], v12 offset:8192
    v_mfma_f32_16x16x32_bf16 v[120:123], v[188:191], v[160:163], v[120:123]
    ds_read_b64_tr_b16 v[202:203], v12 offset:9216
    v_mfma_f32_16x16x32_bf16 v[124:127], v[188:191], v[164:167], v[124:127]
    v_mfma_f32_16x16x32_bf16 v[56:59], v[188:191], v[144:147], v[56:59]
    v_mfma_f32_16x16x32_bf16 v[60:63], v[188:191], v[148:151], v[60:63]
    s_waitcnt lgkmcnt(6)
    ds_read_b64_tr_b16 v[204:205], v13 offset:8192
    v_mfma_f32_16x16x32_bf16 v[128:131], v[192:195], v[160:163], v[128:131]
    ds_read_b64_tr_b16 v[206:207], v13 offset:9216
    v_mfma_f32_16x16x32_bf16 v[132:135], v[192:195], v[164:167], v[132:135]
    v_mfma_f32_16x16x32_bf16 v[64:67], v[192:195], v[144:147], v[64:67]
    v_mfma_f32_16x16x32_bf16 v[68:71], v[192:195], v[148:151], v[68:71]
    s_waitcnt lgkmcnt(4)
    ds_read_b64_tr_b16 v[208:209], v12 offset:8448
    v_mfma_f32_16x16x32_bf16 v[136:139], v[196:199], v[160:163], v[136:139]
    ds_read_b64_tr_b16 v[210:211], v12 offset:9472
    v_mfma_f32_16x16x32_bf16 v[140:143], v[196:199], v[164:167], v[140:143]
    v_mfma_f32_16x16x32_bf16 v[72:75], v[196:199], v[144:147], v[72:75]
    v_mfma_f32_16x16x32_bf16 v[76:79], v[196:199], v[148:151], v[76:79]
    s_waitcnt lgkmcnt(4)
    ds_read_b64_tr_b16 v[176:177], v13 offset:8448
    v_mfma_f32_16x16x32_bf16 v[80:83], v[200:203], v[168:171], v[80:83]
    ds_read_b64_tr_b16 v[178:179], v13 offset:9472
    v_mfma_f32_16x16x32_bf16 v[84:87], v[200:203], v[172:175], v[84:87]
    v_mfma_f32_16x16x32_bf16 v[16:19], v[200:203], v[152:155], v[16:19]
    v_mfma_f32_16x16x32_bf16 v[20:23], v[200:203], v[156:159], v[20:23]
    s_waitcnt lgkmcnt(4)
    ds_read_b64_tr_b16 v[180:181], v12 offset:8704
    v_mfma_f32_16x16x32_bf16 v[88:91], v[204:207], v[168:171], v[88:91]
    ds_read_b64_tr_b16 v[182:183], v12 offset:9728
    v_mfma_f32_16x16x32_bf16 v[92:95], v[204:207], v[172:175], v[92:95]
    v_mfma_f32_16x16x32_bf16 v[24:27], v[204:207], v[152:155], v[24:27]
    v_mfma_f32_16x16x32_bf16 v[28:31], v[204:207], v[156:159], v[28:31]
    s_waitcnt lgkmcnt(4)
    ds_read_b64_tr_b16 v[184:185], v13 offset:8704
    v_mfma_f32_16x16x32_bf16 v[96:99], v[208:211], v[168:171], v[96:99]
    ds_read_b64_tr_b16 v[186:187], v13 offset:9728
    v_mfma_f32_16x16x32_bf16 v[100:103], v[208:211], v[172:175], v[100:103]
    v_mfma_f32_16x16x32_bf16 v[32:35], v[208:211], v[152:155], v[32:35]
    v_mfma_f32_16x16x32_bf16 v[36:39], v[208:211], v[156:159], v[36:39]
    s_waitcnt lgkmcnt(4)
    ds_read_b64_tr_b16 v[188:189], v12 offset:8960
    v_mfma_f32_16x16x32_bf16 v[104:107], v[176:179], v[168:171], v[104:107]
    ds_read_b64_tr_b16 v[190:191], v12 offset:9984
    v_mfma_f32_16x16x32_bf16 v[108:111], v[176:179], v[172:175], v[108:111]
    v_mfma_f32_16x16x32_bf16 v[40:43], v[176:179], v[152:155], v[40:43]
    v_mfma_f32_16x16x32_bf16 v[44:47], v[176:179], v[156:159], v[44:47]
    s_waitcnt lgkmcnt(4)
    ds_read_b64_tr_b16 v[192:193], v13 offset:8960
    v_mfma_f32_16x16x32_bf16 v[112:115], v[180:183], v[168:171], v[112:115]
    ds_read_b64_tr_b16 v[194:195], v13 offset:9984
    v_mfma_f32_16x16x32_bf16 v[116:119], v[180:183], v[172:175], v[116:119]
    v_mfma_f32_16x16x32_bf16 v[48:51], v[180:183], v[152:155], v[48:51]
    v_mfma_f32_16x16x32_bf16 v[52:55], v[180:183], v[156:159], v[52:55]
    s_waitcnt lgkmcnt(4)
    v_mfma_f32_16x16x32_bf16 v[120:123], v[184:187], v[168:171], v[120:123]
    v_mfma_f32_16x16x32_bf16 v[124:127], v[184:187], v[172:175], v[124:127]
    v_mfma_f32_16x16x32_bf16 v[56:59], v[184:187], v[152:155], v[56:59]
    v_mfma_f32_16x16x32_bf16 v[60:63], v[184:187], v[156:159], v[60:63]
    s_waitcnt lgkmcnt(2)
    s_waitcnt lgkmcnt(0)
    s_barrier
    v_add_u32 v14, 0x8800, v14
    v_add_u32 v12, 0xfffef800, v12
    v_add_u32 v13, 0xfffef800, v13
    ds_read_b128 v[160:163], v14 offset:17408
    ds_read_b128 v[164:167], v14 offset:19584
    v_mfma_f32_16x16x32_bf16 v[128:131], v[188:191], v[168:171], v[128:131]
    ds_read_b128 v[144:147], v14 offset:0
    ds_read_b128 v[148:151], v14 offset:2176
    v_mfma_f32_16x16x32_bf16 v[132:135], v[188:191], v[172:175], v[132:135]
    ds_read_b64_tr_b16 v[196:197], v12 offset:0
    ds_read_b64_tr_b16 v[198:199], v12 offset:1024
    v_mfma_f32_16x16x32_bf16 v[64:67], v[188:191], v[152:155], v[64:67]
    ds_read_b64_tr_b16 v[200:201], v13 offset:0
    v_mfma_f32_16x16x32_bf16 v[68:71], v[188:191], v[156:159], v[68:71]
    ds_read_b64_tr_b16 v[202:203], v13 offset:1024
    ds_read_b64_tr_b16 v[204:205], v12 offset:256
    v_mfma_f32_16x16x32_bf16 v[136:139], v[192:195], v[168:171], v[136:139]
    ds_read_b64_tr_b16 v[206:207], v12 offset:1280
    v_mfma_f32_16x16x32_bf16 v[140:143], v[192:195], v[172:175], v[140:143]
    v_mfma_f32_16x16x32_bf16 v[72:75], v[192:195], v[152:155], v[72:75]
    v_mfma_f32_16x16x32_bf16 v[76:79], v[192:195], v[156:159], v[76:79]
    s_waitcnt lgkmcnt(4)
    ds_read_b64_tr_b16 v[208:209], v13 offset:256
    v_mfma_f32_16x16x32_bf16 v[80:83], v[196:199], v[160:163], v[80:83]
    ds_read_b64_tr_b16 v[210:211], v13 offset:1280
    v_mfma_f32_16x16x32_bf16 v[84:87], v[196:199], v[164:167], v[84:87]
    v_mfma_f32_16x16x32_bf16 v[16:19], v[196:199], v[144:147], v[16:19]
    v_mfma_f32_16x16x32_bf16 v[20:23], v[196:199], v[148:151], v[20:23]
    s_waitcnt lgkmcnt(4)
    ds_read_b64_tr_b16 v[176:177], v12 offset:512
    v_mfma_f32_16x16x32_bf16 v[88:91], v[200:203], v[160:163], v[88:91]
    ds_read_b64_tr_b16 v[178:179], v12 offset:1536
    v_mfma_f32_16x16x32_bf16 v[92:95], v[200:203], v[164:167], v[92:95]
    v_mfma_f32_16x16x32_bf16 v[24:27], v[200:203], v[144:147], v[24:27]
    v_mfma_f32_16x16x32_bf16 v[28:31], v[200:203], v[148:151], v[28:31]
    s_waitcnt lgkmcnt(4)
    ds_read_b64_tr_b16 v[180:181], v13 offset:512
    ds_read_b64_tr_b16 v[182:183], v13 offset:1536
    v_mfma_f32_16x16x32_bf16 v[96:99], v[204:207], v[160:163], v[96:99]
    ds_read_b128 v[168:171], v14 offset:17472
    v_mfma_f32_16x16x32_bf16 v[100:103], v[204:207], v[164:167], v[100:103]
    ds_read_b128 v[172:175], v14 offset:19648
    v_mfma_f32_16x16x32_bf16 v[32:35], v[204:207], v[144:147], v[32:35]
    v_mfma_f32_16x16x32_bf16 v[36:39], v[204:207], v[148:151], v[36:39]
    s_waitcnt lgkmcnt(6)
    ds_read_b64_tr_b16 v[184:185], v12 offset:768
    ds_read_b64_tr_b16 v[186:187], v12 offset:1792
    v_mfma_f32_16x16x32_bf16 v[104:107], v[208:211], v[160:163], v[104:107]
    ds_read_b128 v[152:155], v14 offset:64
    v_mfma_f32_16x16x32_bf16 v[108:111], v[208:211], v[164:167], v[108:111]
    ds_read_b128 v[156:159], v14 offset:2240
    v_mfma_f32_16x16x32_bf16 v[40:43], v[208:211], v[144:147], v[40:43]
    v_mfma_f32_16x16x32_bf16 v[44:47], v[208:211], v[148:151], v[44:47]
    s_waitcnt lgkmcnt(8)
    ds_read_b64_tr_b16 v[188:189], v13 offset:768
    v_mfma_f32_16x16x32_bf16 v[112:115], v[176:179], v[160:163], v[112:115]
    ds_read_b64_tr_b16 v[190:191], v13 offset:1792
    v_mfma_f32_16x16x32_bf16 v[116:119], v[176:179], v[164:167], v[116:119]
    v_mfma_f32_16x16x32_bf16 v[48:51], v[176:179], v[144:147], v[48:51]
    v_mfma_f32_16x16x32_bf16 v[52:55], v[176:179], v[148:151], v[52:55]
    s_waitcnt lgkmcnt(8)
    ds_read_b64_tr_b16 v[192:193], v12 offset:8192
    v_mfma_f32_16x16x32_bf16 v[120:123], v[180:183], v[160:163], v[120:123]
    ds_read_b64_tr_b16 v[194:195], v12 offset:9216
    v_mfma_f32_16x16x32_bf16 v[124:127], v[180:183], v[164:167], v[124:127]
    v_mfma_f32_16x16x32_bf16 v[56:59], v[180:183], v[144:147], v[56:59]
    v_mfma_f32_16x16x32_bf16 v[60:63], v[180:183], v[148:151], v[60:63]
    s_waitcnt lgkmcnt(6)
    ds_read_b64_tr_b16 v[196:197], v13 offset:8192
    v_mfma_f32_16x16x32_bf16 v[128:131], v[184:187], v[160:163], v[128:131]
    ds_read_b64_tr_b16 v[198:199], v13 offset:9216
    v_mfma_f32_16x16x32_bf16 v[132:135], v[184:187], v[164:167], v[132:135]
    v_mfma_f32_16x16x32_bf16 v[64:67], v[184:187], v[144:147], v[64:67]
    v_mfma_f32_16x16x32_bf16 v[68:71], v[184:187], v[148:151], v[68:71]
    s_waitcnt lgkmcnt(4)
    ds_read_b64_tr_b16 v[200:201], v12 offset:8448
    v_mfma_f32_16x16x32_bf16 v[136:139], v[188:191], v[160:163], v[136:139]
    ds_read_b64_tr_b16 v[202:203], v12 offset:9472
    v_mfma_f32_16x16x32_bf16 v[140:143], v[188:191], v[164:167], v[140:143]
    v_mfma_f32_16x16x32_bf16 v[72:75], v[188:191], v[144:147], v[72:75]
    v_mfma_f32_16x16x32_bf16 v[76:79], v[188:191], v[148:151], v[76:79]
    s_waitcnt lgkmcnt(4)
    ds_read_b64_tr_b16 v[204:205], v13 offset:8448
    v_mfma_f32_16x16x32_bf16 v[80:83], v[192:195], v[168:171], v[80:83]
    ds_read_b64_tr_b16 v[206:207], v13 offset:9472
    v_mfma_f32_16x16x32_bf16 v[84:87], v[192:195], v[172:175], v[84:87]
    v_mfma_f32_16x16x32_bf16 v[16:19], v[192:195], v[152:155], v[16:19]
    v_mfma_f32_16x16x32_bf16 v[20:23], v[192:195], v[156:159], v[20:23]
    s_waitcnt lgkmcnt(4)
    ds_read_b64_tr_b16 v[208:209], v12 offset:8704
    v_mfma_f32_16x16x32_bf16 v[88:91], v[196:199], v[168:171], v[88:91]
    ds_read_b64_tr_b16 v[210:211], v12 offset:9728
    v_mfma_f32_16x16x32_bf16 v[92:95], v[196:199], v[172:175], v[92:95]
    v_mfma_f32_16x16x32_bf16 v[24:27], v[196:199], v[152:155], v[24:27]
    v_mfma_f32_16x16x32_bf16 v[28:31], v[196:199], v[156:159], v[28:31]
    s_waitcnt lgkmcnt(4)
    ds_read_b64_tr_b16 v[176:177], v13 offset:8704
    v_mfma_f32_16x16x32_bf16 v[96:99], v[200:203], v[168:171], v[96:99]
    ds_read_b64_tr_b16 v[178:179], v13 offset:9728
    v_mfma_f32_16x16x32_bf16 v[100:103], v[200:203], v[172:175], v[100:103]
    v_mfma_f32_16x16x32_bf16 v[32:35], v[200:203], v[152:155], v[32:35]
    v_mfma_f32_16x16x32_bf16 v[36:39], v[200:203], v[156:159], v[36:39]
    s_waitcnt lgkmcnt(4)
    ds_read_b64_tr_b16 v[180:181], v12 offset:8960
    v_mfma_f32_16x16x32_bf16 v[104:107], v[204:207], v[168:171], v[104:107]
    ds_read_b64_tr_b16 v[182:183], v12 offset:9984
    v_mfma_f32_16x16x32_bf16 v[108:111], v[204:207], v[172:175], v[108:111]
    v_mfma_f32_16x16x32_bf16 v[40:43], v[204:207], v[152:155], v[40:43]
    v_mfma_f32_16x16x32_bf16 v[44:47], v[204:207], v[156:159], v[44:47]
    s_waitcnt lgkmcnt(4)
    ds_read_b64_tr_b16 v[184:185], v13 offset:8960
    v_mfma_f32_16x16x32_bf16 v[112:115], v[208:211], v[168:171], v[112:115]
    ds_read_b64_tr_b16 v[186:187], v13 offset:9984
    v_mfma_f32_16x16x32_bf16 v[116:119], v[208:211], v[172:175], v[116:119]
    v_mfma_f32_16x16x32_bf16 v[48:51], v[208:211], v[152:155], v[48:51]
    v_mfma_f32_16x16x32_bf16 v[52:55], v[208:211], v[156:159], v[52:55]
    s_waitcnt lgkmcnt(4)
    v_mfma_f32_16x16x32_bf16 v[120:123], v[176:179], v[168:171], v[120:123]
    v_mfma_f32_16x16x32_bf16 v[124:127], v[176:179], v[172:175], v[124:127]
    v_mfma_f32_16x16x32_bf16 v[56:59], v[176:179], v[152:155], v[56:59]
    v_mfma_f32_16x16x32_bf16 v[60:63], v[176:179], v[156:159], v[60:63]
    s_waitcnt lgkmcnt(2)
    s_waitcnt lgkmcnt(0)
    s_barrier
    v_add_u32 v14, 0xc800, v14
    v_add_u32 v12, 0xc800, v12
    v_add_u32 v13, 0xc800, v13
    ds_read_b128 v[160:163], v14 offset:17408
    ds_read_b128 v[164:167], v14 offset:19584
    v_mfma_f32_16x16x32_bf16 v[128:131], v[180:183], v[168:171], v[128:131]
    ds_read_b128 v[144:147], v14 offset:0
    ds_read_b128 v[148:151], v14 offset:2176
    v_mfma_f32_16x16x32_bf16 v[132:135], v[180:183], v[172:175], v[132:135]
    ds_read_b64_tr_b16 v[188:189], v12 offset:0
    ds_read_b64_tr_b16 v[190:191], v12 offset:1024
    v_mfma_f32_16x16x32_bf16 v[64:67], v[180:183], v[152:155], v[64:67]
    ds_read_b64_tr_b16 v[192:193], v13 offset:0
    v_mfma_f32_16x16x32_bf16 v[68:71], v[180:183], v[156:159], v[68:71]
    ds_read_b64_tr_b16 v[194:195], v13 offset:1024
    ds_read_b64_tr_b16 v[196:197], v12 offset:256
    v_mfma_f32_16x16x32_bf16 v[136:139], v[184:187], v[168:171], v[136:139]
    ds_read_b64_tr_b16 v[198:199], v12 offset:1280
    v_mfma_f32_16x16x32_bf16 v[140:143], v[184:187], v[172:175], v[140:143]
    v_mfma_f32_16x16x32_bf16 v[72:75], v[184:187], v[152:155], v[72:75]
    v_mfma_f32_16x16x32_bf16 v[76:79], v[184:187], v[156:159], v[76:79]
    s_waitcnt lgkmcnt(4)
    ds_read_b64_tr_b16 v[200:201], v13 offset:256
    v_mfma_f32_16x16x32_bf16 v[80:83], v[188:191], v[160:163], v[80:83]
    ds_read_b64_tr_b16 v[202:203], v13 offset:1280
    v_mfma_f32_16x16x32_bf16 v[84:87], v[188:191], v[164:167], v[84:87]
    v_mfma_f32_16x16x32_bf16 v[16:19], v[188:191], v[144:147], v[16:19]
    v_mfma_f32_16x16x32_bf16 v[20:23], v[188:191], v[148:151], v[20:23]
    s_waitcnt lgkmcnt(4)
    ds_read_b64_tr_b16 v[204:205], v12 offset:512
    v_mfma_f32_16x16x32_bf16 v[88:91], v[192:195], v[160:163], v[88:91]
    ds_read_b64_tr_b16 v[206:207], v12 offset:1536
    v_mfma_f32_16x16x32_bf16 v[92:95], v[192:195], v[164:167], v[92:95]
    v_mfma_f32_16x16x32_bf16 v[24:27], v[192:195], v[144:147], v[24:27]
    v_mfma_f32_16x16x32_bf16 v[28:31], v[192:195], v[148:151], v[28:31]
    s_waitcnt lgkmcnt(4)
    ds_read_b64_tr_b16 v[208:209], v13 offset:512
    ds_read_b64_tr_b16 v[210:211], v13 offset:1536
    v_mfma_f32_16x16x32_bf16 v[96:99], v[196:199], v[160:163], v[96:99]
    ds_read_b128 v[168:171], v14 offset:17472
    v_mfma_f32_16x16x32_bf16 v[100:103], v[196:199], v[164:167], v[100:103]
    ds_read_b128 v[172:175], v14 offset:19648
    v_mfma_f32_16x16x32_bf16 v[32:35], v[196:199], v[144:147], v[32:35]
    v_mfma_f32_16x16x32_bf16 v[36:39], v[196:199], v[148:151], v[36:39]
    s_waitcnt lgkmcnt(6)
    ds_read_b64_tr_b16 v[176:177], v12 offset:768
    ds_read_b64_tr_b16 v[178:179], v12 offset:1792
    v_mfma_f32_16x16x32_bf16 v[104:107], v[200:203], v[160:163], v[104:107]
    ds_read_b128 v[152:155], v14 offset:64
    v_mfma_f32_16x16x32_bf16 v[108:111], v[200:203], v[164:167], v[108:111]
    ds_read_b128 v[156:159], v14 offset:2240
    v_mfma_f32_16x16x32_bf16 v[40:43], v[200:203], v[144:147], v[40:43]
    v_mfma_f32_16x16x32_bf16 v[44:47], v[200:203], v[148:151], v[44:47]
    s_waitcnt lgkmcnt(8)
    ds_read_b64_tr_b16 v[180:181], v13 offset:768
    v_mfma_f32_16x16x32_bf16 v[112:115], v[204:207], v[160:163], v[112:115]
    ds_read_b64_tr_b16 v[182:183], v13 offset:1792
    v_mfma_f32_16x16x32_bf16 v[116:119], v[204:207], v[164:167], v[116:119]
    v_mfma_f32_16x16x32_bf16 v[48:51], v[204:207], v[144:147], v[48:51]
    v_mfma_f32_16x16x32_bf16 v[52:55], v[204:207], v[148:151], v[52:55]
    s_waitcnt lgkmcnt(8)
    ds_read_b64_tr_b16 v[184:185], v12 offset:8192
    v_mfma_f32_16x16x32_bf16 v[120:123], v[208:211], v[160:163], v[120:123]
    ds_read_b64_tr_b16 v[186:187], v12 offset:9216
    v_mfma_f32_16x16x32_bf16 v[124:127], v[208:211], v[164:167], v[124:127]
    v_mfma_f32_16x16x32_bf16 v[56:59], v[208:211], v[144:147], v[56:59]
    v_mfma_f32_16x16x32_bf16 v[60:63], v[208:211], v[148:151], v[60:63]
    s_waitcnt lgkmcnt(6)
    ds_read_b64_tr_b16 v[188:189], v13 offset:8192
    v_mfma_f32_16x16x32_bf16 v[128:131], v[176:179], v[160:163], v[128:131]
    ds_read_b64_tr_b16 v[190:191], v13 offset:9216
    v_mfma_f32_16x16x32_bf16 v[132:135], v[176:179], v[164:167], v[132:135]
    v_mfma_f32_16x16x32_bf16 v[64:67], v[176:179], v[144:147], v[64:67]
    v_mfma_f32_16x16x32_bf16 v[68:71], v[176:179], v[148:151], v[68:71]
    s_waitcnt lgkmcnt(4)
    ds_read_b64_tr_b16 v[192:193], v12 offset:8448
    v_mfma_f32_16x16x32_bf16 v[136:139], v[180:183], v[160:163], v[136:139]
    ds_read_b64_tr_b16 v[194:195], v12 offset:9472
    v_mfma_f32_16x16x32_bf16 v[140:143], v[180:183], v[164:167], v[140:143]
    v_mfma_f32_16x16x32_bf16 v[72:75], v[180:183], v[144:147], v[72:75]
    v_mfma_f32_16x16x32_bf16 v[76:79], v[180:183], v[148:151], v[76:79]
    s_waitcnt lgkmcnt(4)
    ds_read_b64_tr_b16 v[196:197], v13 offset:8448
    v_mfma_f32_16x16x32_bf16 v[80:83], v[184:187], v[168:171], v[80:83]
    ds_read_b64_tr_b16 v[198:199], v13 offset:9472
    v_mfma_f32_16x16x32_bf16 v[84:87], v[184:187], v[172:175], v[84:87]
    v_mfma_f32_16x16x32_bf16 v[16:19], v[184:187], v[152:155], v[16:19]
    v_mfma_f32_16x16x32_bf16 v[20:23], v[184:187], v[156:159], v[20:23]
    s_waitcnt lgkmcnt(4)
    ds_read_b64_tr_b16 v[200:201], v12 offset:8704
    v_mfma_f32_16x16x32_bf16 v[88:91], v[188:191], v[168:171], v[88:91]
    ds_read_b64_tr_b16 v[202:203], v12 offset:9728
    v_mfma_f32_16x16x32_bf16 v[92:95], v[188:191], v[172:175], v[92:95]
    v_mfma_f32_16x16x32_bf16 v[24:27], v[188:191], v[152:155], v[24:27]
    v_mfma_f32_16x16x32_bf16 v[28:31], v[188:191], v[156:159], v[28:31]
    s_waitcnt lgkmcnt(4)
    ds_read_b64_tr_b16 v[204:205], v13 offset:8704
    v_mfma_f32_16x16x32_bf16 v[96:99], v[192:195], v[168:171], v[96:99]
    ds_read_b64_tr_b16 v[206:207], v13 offset:9728
    v_mfma_f32_16x16x32_bf16 v[100:103], v[192:195], v[172:175], v[100:103]
    v_mfma_f32_16x16x32_bf16 v[32:35], v[192:195], v[152:155], v[32:35]
    v_mfma_f32_16x16x32_bf16 v[36:39], v[192:195], v[156:159], v[36:39]
    s_waitcnt lgkmcnt(4)
    ds_read_b64_tr_b16 v[208:209], v12 offset:8960
    v_mfma_f32_16x16x32_bf16 v[104:107], v[196:199], v[168:171], v[104:107]
    ds_read_b64_tr_b16 v[210:211], v12 offset:9984
    v_mfma_f32_16x16x32_bf16 v[108:111], v[196:199], v[172:175], v[108:111]
    v_mfma_f32_16x16x32_bf16 v[40:43], v[196:199], v[152:155], v[40:43]
    v_mfma_f32_16x16x32_bf16 v[44:47], v[196:199], v[156:159], v[44:47]
    s_waitcnt lgkmcnt(4)
    ds_read_b64_tr_b16 v[176:177], v13 offset:8960
    v_mfma_f32_16x16x32_bf16 v[112:115], v[200:203], v[168:171], v[112:115]
    ds_read_b64_tr_b16 v[178:179], v13 offset:9984
    v_mfma_f32_16x16x32_bf16 v[116:119], v[200:203], v[172:175], v[116:119]
    v_mfma_f32_16x16x32_bf16 v[48:51], v[200:203], v[152:155], v[48:51]
    v_mfma_f32_16x16x32_bf16 v[52:55], v[200:203], v[156:159], v[52:55]
    s_waitcnt lgkmcnt(4)
    v_mfma_f32_16x16x32_bf16 v[120:123], v[204:207], v[168:171], v[120:123]
    v_mfma_f32_16x16x32_bf16 v[124:127], v[204:207], v[172:175], v[124:127]
    v_mfma_f32_16x16x32_bf16 v[56:59], v[204:207], v[152:155], v[56:59]
    v_mfma_f32_16x16x32_bf16 v[60:63], v[204:207], v[156:159], v[60:63]
    s_waitcnt lgkmcnt(2)
    s_waitcnt lgkmcnt(0)
    s_barrier
    v_add_u32 v14, 0xfffeb000, v14
    v_add_u32 v12, 0x4000, v12
    v_add_u32 v13, 0x4000, v13
    ds_read_b128 v[160:163], v14 offset:17408
    ds_read_b128 v[164:167], v14 offset:19584
    v_mfma_f32_16x16x32_bf16 v[128:131], v[208:211], v[168:171], v[128:131]
    ds_read_b128 v[144:147], v14 offset:0
    ds_read_b128 v[148:151], v14 offset:2176
    v_mfma_f32_16x16x32_bf16 v[132:135], v[208:211], v[172:175], v[132:135]
    ds_read_b64_tr_b16 v[180:181], v12 offset:0
    ds_read_b64_tr_b16 v[182:183], v12 offset:1024
    v_mfma_f32_16x16x32_bf16 v[64:67], v[208:211], v[152:155], v[64:67]
    ds_read_b64_tr_b16 v[184:185], v13 offset:0
    v_mfma_f32_16x16x32_bf16 v[68:71], v[208:211], v[156:159], v[68:71]
    ds_read_b64_tr_b16 v[186:187], v13 offset:1024
    ds_read_b64_tr_b16 v[188:189], v12 offset:256
    v_mfma_f32_16x16x32_bf16 v[136:139], v[176:179], v[168:171], v[136:139]
    ds_read_b64_tr_b16 v[190:191], v12 offset:1280
    v_mfma_f32_16x16x32_bf16 v[140:143], v[176:179], v[172:175], v[140:143]
    v_mfma_f32_16x16x32_bf16 v[72:75], v[176:179], v[152:155], v[72:75]
    v_mfma_f32_16x16x32_bf16 v[76:79], v[176:179], v[156:159], v[76:79]
    s_waitcnt lgkmcnt(4)
    ds_read_b64_tr_b16 v[192:193], v13 offset:256
    v_mfma_f32_16x16x32_bf16 v[80:83], v[180:183], v[160:163], v[80:83]
    ds_read_b64_tr_b16 v[194:195], v13 offset:1280
    v_mfma_f32_16x16x32_bf16 v[84:87], v[180:183], v[164:167], v[84:87]
    v_mfma_f32_16x16x32_bf16 v[16:19], v[180:183], v[144:147], v[16:19]
    v_mfma_f32_16x16x32_bf16 v[20:23], v[180:183], v[148:151], v[20:23]
    s_waitcnt lgkmcnt(4)
    ds_read_b64_tr_b16 v[196:197], v12 offset:512
    v_mfma_f32_16x16x32_bf16 v[88:91], v[184:187], v[160:163], v[88:91]
    ds_read_b64_tr_b16 v[198:199], v12 offset:1536
    v_mfma_f32_16x16x32_bf16 v[92:95], v[184:187], v[164:167], v[92:95]
    v_mfma_f32_16x16x32_bf16 v[24:27], v[184:187], v[144:147], v[24:27]
    v_mfma_f32_16x16x32_bf16 v[28:31], v[184:187], v[148:151], v[28:31]
    s_waitcnt lgkmcnt(4)
    ds_read_b64_tr_b16 v[200:201], v13 offset:512
    ds_read_b64_tr_b16 v[202:203], v13 offset:1536
    v_mfma_f32_16x16x32_bf16 v[96:99], v[188:191], v[160:163], v[96:99]
    ds_read_b128 v[168:171], v14 offset:17472
    v_mfma_f32_16x16x32_bf16 v[100:103], v[188:191], v[164:167], v[100:103]
    ds_read_b128 v[172:175], v14 offset:19648
    v_mfma_f32_16x16x32_bf16 v[32:35], v[188:191], v[144:147], v[32:35]
    v_mfma_f32_16x16x32_bf16 v[36:39], v[188:191], v[148:151], v[36:39]
    s_waitcnt lgkmcnt(6)
    ds_read_b64_tr_b16 v[204:205], v12 offset:768
    ds_read_b64_tr_b16 v[206:207], v12 offset:1792
    v_mfma_f32_16x16x32_bf16 v[104:107], v[192:195], v[160:163], v[104:107]
    ds_read_b128 v[152:155], v14 offset:64
    v_mfma_f32_16x16x32_bf16 v[108:111], v[192:195], v[164:167], v[108:111]
    ds_read_b128 v[156:159], v14 offset:2240
    v_mfma_f32_16x16x32_bf16 v[40:43], v[192:195], v[144:147], v[40:43]
    v_mfma_f32_16x16x32_bf16 v[44:47], v[192:195], v[148:151], v[44:47]
    s_waitcnt lgkmcnt(8)
    ds_read_b64_tr_b16 v[208:209], v13 offset:768
    v_mfma_f32_16x16x32_bf16 v[112:115], v[196:199], v[160:163], v[112:115]
    ds_read_b64_tr_b16 v[210:211], v13 offset:1792
    v_mfma_f32_16x16x32_bf16 v[116:119], v[196:199], v[164:167], v[116:119]
    v_mfma_f32_16x16x32_bf16 v[48:51], v[196:199], v[144:147], v[48:51]
    v_mfma_f32_16x16x32_bf16 v[52:55], v[196:199], v[148:151], v[52:55]
    s_waitcnt lgkmcnt(8)
    ds_read_b64_tr_b16 v[176:177], v12 offset:8192
    v_mfma_f32_16x16x32_bf16 v[120:123], v[200:203], v[160:163], v[120:123]
    ds_read_b64_tr_b16 v[178:179], v12 offset:9216
    v_mfma_f32_16x16x32_bf16 v[124:127], v[200:203], v[164:167], v[124:127]
    v_mfma_f32_16x16x32_bf16 v[56:59], v[200:203], v[144:147], v[56:59]
    v_mfma_f32_16x16x32_bf16 v[60:63], v[200:203], v[148:151], v[60:63]
    s_waitcnt lgkmcnt(6)
    ds_read_b64_tr_b16 v[180:181], v13 offset:8192
    v_mfma_f32_16x16x32_bf16 v[128:131], v[204:207], v[160:163], v[128:131]
    ds_read_b64_tr_b16 v[182:183], v13 offset:9216
    v_mfma_f32_16x16x32_bf16 v[132:135], v[204:207], v[164:167], v[132:135]
    v_mfma_f32_16x16x32_bf16 v[64:67], v[204:207], v[144:147], v[64:67]
    v_mfma_f32_16x16x32_bf16 v[68:71], v[204:207], v[148:151], v[68:71]
    s_waitcnt lgkmcnt(4)
    ds_read_b64_tr_b16 v[184:185], v12 offset:8448
    v_mfma_f32_16x16x32_bf16 v[136:139], v[208:211], v[160:163], v[136:139]
    ds_read_b64_tr_b16 v[186:187], v12 offset:9472
    v_mfma_f32_16x16x32_bf16 v[140:143], v[208:211], v[164:167], v[140:143]
    v_mfma_f32_16x16x32_bf16 v[72:75], v[208:211], v[144:147], v[72:75]
    v_mfma_f32_16x16x32_bf16 v[76:79], v[208:211], v[148:151], v[76:79]
    s_waitcnt lgkmcnt(4)
    ds_read_b64_tr_b16 v[188:189], v13 offset:8448
    v_mfma_f32_16x16x32_bf16 v[80:83], v[176:179], v[168:171], v[80:83]
    ds_read_b64_tr_b16 v[190:191], v13 offset:9472
    v_mfma_f32_16x16x32_bf16 v[84:87], v[176:179], v[172:175], v[84:87]
    v_mfma_f32_16x16x32_bf16 v[16:19], v[176:179], v[152:155], v[16:19]
    v_mfma_f32_16x16x32_bf16 v[20:23], v[176:179], v[156:159], v[20:23]
    s_waitcnt lgkmcnt(4)
    ds_read_b64_tr_b16 v[192:193], v12 offset:8704
    v_mfma_f32_16x16x32_bf16 v[88:91], v[180:183], v[168:171], v[88:91]
    ds_read_b64_tr_b16 v[194:195], v12 offset:9728
    v_mfma_f32_16x16x32_bf16 v[92:95], v[180:183], v[172:175], v[92:95]
    v_mfma_f32_16x16x32_bf16 v[24:27], v[180:183], v[152:155], v[24:27]
    v_mfma_f32_16x16x32_bf16 v[28:31], v[180:183], v[156:159], v[28:31]
    s_waitcnt lgkmcnt(4)
    ds_read_b64_tr_b16 v[196:197], v13 offset:8704
    v_mfma_f32_16x16x32_bf16 v[96:99], v[184:187], v[168:171], v[96:99]
    ds_read_b64_tr_b16 v[198:199], v13 offset:9728
    v_mfma_f32_16x16x32_bf16 v[100:103], v[184:187], v[172:175], v[100:103]
    v_mfma_f32_16x16x32_bf16 v[32:35], v[184:187], v[152:155], v[32:35]
    v_mfma_f32_16x16x32_bf16 v[36:39], v[184:187], v[156:159], v[36:39]
    s_waitcnt lgkmcnt(4)
    ds_read_b64_tr_b16 v[200:201], v12 offset:8960
    v_mfma_f32_16x16x32_bf16 v[104:107], v[188:191], v[168:171], v[104:107]
    ds_read_b64_tr_b16 v[202:203], v12 offset:9984
    v_mfma_f32_16x16x32_bf16 v[108:111], v[188:191], v[172:175], v[108:111]
    v_mfma_f32_16x16x32_bf16 v[40:43], v[188:191], v[152:155], v[40:43]
    v_mfma_f32_16x16x32_bf16 v[44:47], v[188:191], v[156:159], v[44:47]
    s_waitcnt lgkmcnt(4)
    ds_read_b64_tr_b16 v[204:205], v13 offset:8960
    v_mfma_f32_16x16x32_bf16 v[112:115], v[192:195], v[168:171], v[112:115]
    ds_read_b64_tr_b16 v[206:207], v13 offset:9984
    v_mfma_f32_16x16x32_bf16 v[116:119], v[192:195], v[172:175], v[116:119]
    v_mfma_f32_16x16x32_bf16 v[48:51], v[192:195], v[152:155], v[48:51]
    v_mfma_f32_16x16x32_bf16 v[52:55], v[192:195], v[156:159], v[52:55]
    s_waitcnt lgkmcnt(4)
    v_mfma_f32_16x16x32_bf16 v[120:123], v[196:199], v[168:171], v[120:123]
    v_mfma_f32_16x16x32_bf16 v[124:127], v[196:199], v[172:175], v[124:127]
    v_mfma_f32_16x16x32_bf16 v[56:59], v[196:199], v[152:155], v[56:59]
    v_mfma_f32_16x16x32_bf16 v[60:63], v[196:199], v[156:159], v[60:63]
    s_waitcnt lgkmcnt(2)
    s_waitcnt lgkmcnt(0)
    s_barrier
    v_add_u32 v14, 0x8800, v14
    v_add_u32 v12, 0xfffef800, v12
    v_add_u32 v13, 0xfffef800, v13
    ds_read_b128 v[160:163], v14 offset:17408
    ds_read_b128 v[164:167], v14 offset:19584
    v_mfma_f32_16x16x32_bf16 v[128:131], v[200:203], v[168:171], v[128:131]
    ds_read_b128 v[144:147], v14 offset:0
    ds_read_b128 v[148:151], v14 offset:2176
    v_mfma_f32_16x16x32_bf16 v[132:135], v[200:203], v[172:175], v[132:135]
    ds_read_b64_tr_b16 v[208:209], v12 offset:0
    ds_read_b64_tr_b16 v[210:211], v12 offset:1024
    v_mfma_f32_16x16x32_bf16 v[64:67], v[200:203], v[152:155], v[64:67]
    ds_read_b64_tr_b16 v[176:177], v13 offset:0
    v_mfma_f32_16x16x32_bf16 v[68:71], v[200:203], v[156:159], v[68:71]
    ds_read_b64_tr_b16 v[178:179], v13 offset:1024
    ds_read_b64_tr_b16 v[180:181], v12 offset:256
    v_mfma_f32_16x16x32_bf16 v[136:139], v[204:207], v[168:171], v[136:139]
    ds_read_b64_tr_b16 v[182:183], v12 offset:1280
    v_mfma_f32_16x16x32_bf16 v[140:143], v[204:207], v[172:175], v[140:143]
    v_mfma_f32_16x16x32_bf16 v[72:75], v[204:207], v[152:155], v[72:75]
    v_mfma_f32_16x16x32_bf16 v[76:79], v[204:207], v[156:159], v[76:79]
    s_waitcnt lgkmcnt(4)
    ds_read_b64_tr_b16 v[184:185], v13 offset:256
    v_mfma_f32_16x16x32_bf16 v[80:83], v[208:211], v[160:163], v[80:83]
    ds_read_b64_tr_b16 v[186:187], v13 offset:1280
    v_mfma_f32_16x16x32_bf16 v[84:87], v[208:211], v[164:167], v[84:87]
    v_mfma_f32_16x16x32_bf16 v[16:19], v[208:211], v[144:147], v[16:19]
    v_mfma_f32_16x16x32_bf16 v[20:23], v[208:211], v[148:151], v[20:23]
    s_waitcnt lgkmcnt(4)
    ds_read_b64_tr_b16 v[188:189], v12 offset:512
    v_mfma_f32_16x16x32_bf16 v[88:91], v[176:179], v[160:163], v[88:91]
    ds_read_b64_tr_b16 v[190:191], v12 offset:1536
    v_mfma_f32_16x16x32_bf16 v[92:95], v[176:179], v[164:167], v[92:95]
    v_mfma_f32_16x16x32_bf16 v[24:27], v[176:179], v[144:147], v[24:27]
    v_mfma_f32_16x16x32_bf16 v[28:31], v[176:179], v[148:151], v[28:31]
    s_waitcnt lgkmcnt(4)
    ds_read_b64_tr_b16 v[192:193], v13 offset:512
    ds_read_b64_tr_b16 v[194:195], v13 offset:1536
    v_mfma_f32_16x16x32_bf16 v[96:99], v[180:183], v[160:163], v[96:99]
    ds_read_b128 v[168:171], v14 offset:17472
    v_mfma_f32_16x16x32_bf16 v[100:103], v[180:183], v[164:167], v[100:103]
    ds_read_b128 v[172:175], v14 offset:19648
    v_mfma_f32_16x16x32_bf16 v[32:35], v[180:183], v[144:147], v[32:35]
    v_mfma_f32_16x16x32_bf16 v[36:39], v[180:183], v[148:151], v[36:39]
    s_waitcnt lgkmcnt(6)
    ds_read_b64_tr_b16 v[196:197], v12 offset:768
    ds_read_b64_tr_b16 v[198:199], v12 offset:1792
    v_mfma_f32_16x16x32_bf16 v[104:107], v[184:187], v[160:163], v[104:107]
    ds_read_b128 v[152:155], v14 offset:64
    v_mfma_f32_16x16x32_bf16 v[108:111], v[184:187], v[164:167], v[108:111]
    ds_read_b128 v[156:159], v14 offset:2240
    v_mfma_f32_16x16x32_bf16 v[40:43], v[184:187], v[144:147], v[40:43]
    v_mfma_f32_16x16x32_bf16 v[44:47], v[184:187], v[148:151], v[44:47]
    s_waitcnt lgkmcnt(8)
    ds_read_b64_tr_b16 v[200:201], v13 offset:768
    v_mfma_f32_16x16x32_bf16 v[112:115], v[188:191], v[160:163], v[112:115]
    ds_read_b64_tr_b16 v[202:203], v13 offset:1792
    v_mfma_f32_16x16x32_bf16 v[116:119], v[188:191], v[164:167], v[116:119]
    v_mfma_f32_16x16x32_bf16 v[48:51], v[188:191], v[144:147], v[48:51]
    v_mfma_f32_16x16x32_bf16 v[52:55], v[188:191], v[148:151], v[52:55]
    s_waitcnt lgkmcnt(8)
    ds_read_b64_tr_b16 v[204:205], v12 offset:8192
    v_mfma_f32_16x16x32_bf16 v[120:123], v[192:195], v[160:163], v[120:123]
    ds_read_b64_tr_b16 v[206:207], v12 offset:9216
    v_mfma_f32_16x16x32_bf16 v[124:127], v[192:195], v[164:167], v[124:127]
    v_mfma_f32_16x16x32_bf16 v[56:59], v[192:195], v[144:147], v[56:59]
    v_mfma_f32_16x16x32_bf16 v[60:63], v[192:195], v[148:151], v[60:63]
    s_waitcnt lgkmcnt(6)
    ds_read_b64_tr_b16 v[208:209], v13 offset:8192
    v_mfma_f32_16x16x32_bf16 v[128:131], v[196:199], v[160:163], v[128:131]
    ds_read_b64_tr_b16 v[210:211], v13 offset:9216
    v_mfma_f32_16x16x32_bf16 v[132:135], v[196:199], v[164:167], v[132:135]
    v_mfma_f32_16x16x32_bf16 v[64:67], v[196:199], v[144:147], v[64:67]
    v_mfma_f32_16x16x32_bf16 v[68:71], v[196:199], v[148:151], v[68:71]
    s_waitcnt lgkmcnt(4)
    ds_read_b64_tr_b16 v[176:177], v12 offset:8448
    v_mfma_f32_16x16x32_bf16 v[136:139], v[200:203], v[160:163], v[136:139]
    ds_read_b64_tr_b16 v[178:179], v12 offset:9472
    v_mfma_f32_16x16x32_bf16 v[140:143], v[200:203], v[164:167], v[140:143]
    v_mfma_f32_16x16x32_bf16 v[72:75], v[200:203], v[144:147], v[72:75]
    v_mfma_f32_16x16x32_bf16 v[76:79], v[200:203], v[148:151], v[76:79]
    s_waitcnt lgkmcnt(4)
    ds_read_b64_tr_b16 v[180:181], v13 offset:8448
    v_mfma_f32_16x16x32_bf16 v[80:83], v[204:207], v[168:171], v[80:83]
    ds_read_b64_tr_b16 v[182:183], v13 offset:9472
    v_mfma_f32_16x16x32_bf16 v[84:87], v[204:207], v[172:175], v[84:87]
    v_mfma_f32_16x16x32_bf16 v[16:19], v[204:207], v[152:155], v[16:19]
    v_mfma_f32_16x16x32_bf16 v[20:23], v[204:207], v[156:159], v[20:23]
    s_waitcnt lgkmcnt(4)
    ds_read_b64_tr_b16 v[184:185], v12 offset:8704
    v_mfma_f32_16x16x32_bf16 v[88:91], v[208:211], v[168:171], v[88:91]
    ds_read_b64_tr_b16 v[186:187], v12 offset:9728
    v_mfma_f32_16x16x32_bf16 v[92:95], v[208:211], v[172:175], v[92:95]
    v_mfma_f32_16x16x32_bf16 v[24:27], v[208:211], v[152:155], v[24:27]
    v_mfma_f32_16x16x32_bf16 v[28:31], v[208:211], v[156:159], v[28:31]
    s_waitcnt lgkmcnt(4)
    ds_read_b64_tr_b16 v[188:189], v13 offset:8704
    v_mfma_f32_16x16x32_bf16 v[96:99], v[176:179], v[168:171], v[96:99]
    ds_read_b64_tr_b16 v[190:191], v13 offset:9728
    v_mfma_f32_16x16x32_bf16 v[100:103], v[176:179], v[172:175], v[100:103]
    v_mfma_f32_16x16x32_bf16 v[32:35], v[176:179], v[152:155], v[32:35]
    v_mfma_f32_16x16x32_bf16 v[36:39], v[176:179], v[156:159], v[36:39]
    s_waitcnt lgkmcnt(4)
    ds_read_b64_tr_b16 v[192:193], v12 offset:8960
    v_mfma_f32_16x16x32_bf16 v[104:107], v[180:183], v[168:171], v[104:107]
    ds_read_b64_tr_b16 v[194:195], v12 offset:9984
    v_mfma_f32_16x16x32_bf16 v[108:111], v[180:183], v[172:175], v[108:111]
    v_mfma_f32_16x16x32_bf16 v[40:43], v[180:183], v[152:155], v[40:43]
    v_mfma_f32_16x16x32_bf16 v[44:47], v[180:183], v[156:159], v[44:47]
    s_waitcnt lgkmcnt(4)
    ds_read_b64_tr_b16 v[196:197], v13 offset:8960
    v_mfma_f32_16x16x32_bf16 v[112:115], v[184:187], v[168:171], v[112:115]
    ds_read_b64_tr_b16 v[198:199], v13 offset:9984
    v_mfma_f32_16x16x32_bf16 v[116:119], v[184:187], v[172:175], v[116:119]
    v_mfma_f32_16x16x32_bf16 v[48:51], v[184:187], v[152:155], v[48:51]
    v_mfma_f32_16x16x32_bf16 v[52:55], v[184:187], v[156:159], v[52:55]
    s_waitcnt lgkmcnt(4)
    v_mfma_f32_16x16x32_bf16 v[120:123], v[188:191], v[168:171], v[120:123]
    v_mfma_f32_16x16x32_bf16 v[124:127], v[188:191], v[172:175], v[124:127]
    v_mfma_f32_16x16x32_bf16 v[56:59], v[188:191], v[152:155], v[56:59]
    v_mfma_f32_16x16x32_bf16 v[60:63], v[188:191], v[156:159], v[60:63]
    s_waitcnt lgkmcnt(2)
    s_waitcnt lgkmcnt(0)
    s_barrier
    v_add_u32 v14, 0xc800, v14
    v_add_u32 v12, 0xc800, v12
    v_add_u32 v13, 0xc800, v13
    ds_read_b128 v[160:163], v14 offset:17408
    ds_read_b128 v[164:167], v14 offset:19584
    v_mfma_f32_16x16x32_bf16 v[128:131], v[192:195], v[168:171], v[128:131]
    ds_read_b128 v[144:147], v14 offset:0
    ds_read_b128 v[148:151], v14 offset:2176
    v_mfma_f32_16x16x32_bf16 v[132:135], v[192:195], v[172:175], v[132:135]
    ds_read_b64_tr_b16 v[200:201], v12 offset:0
    ds_read_b64_tr_b16 v[202:203], v12 offset:1024
    v_mfma_f32_16x16x32_bf16 v[64:67], v[192:195], v[152:155], v[64:67]
    ds_read_b64_tr_b16 v[204:205], v13 offset:0
    v_mfma_f32_16x16x32_bf16 v[68:71], v[192:195], v[156:159], v[68:71]
    ds_read_b64_tr_b16 v[206:207], v13 offset:1024
    ds_read_b64_tr_b16 v[208:209], v12 offset:256
    v_mfma_f32_16x16x32_bf16 v[136:139], v[196:199], v[168:171], v[136:139]
    ds_read_b64_tr_b16 v[210:211], v12 offset:1280
    v_mfma_f32_16x16x32_bf16 v[140:143], v[196:199], v[172:175], v[140:143]
    v_mfma_f32_16x16x32_bf16 v[72:75], v[196:199], v[152:155], v[72:75]
    v_mfma_f32_16x16x32_bf16 v[76:79], v[196:199], v[156:159], v[76:79]
    s_waitcnt lgkmcnt(4)
    ds_read_b64_tr_b16 v[176:177], v13 offset:256
    v_mfma_f32_16x16x32_bf16 v[80:83], v[200:203], v[160:163], v[80:83]
    ds_read_b64_tr_b16 v[178:179], v13 offset:1280
    v_mfma_f32_16x16x32_bf16 v[84:87], v[200:203], v[164:167], v[84:87]
    v_mfma_f32_16x16x32_bf16 v[16:19], v[200:203], v[144:147], v[16:19]
    v_mfma_f32_16x16x32_bf16 v[20:23], v[200:203], v[148:151], v[20:23]
    s_waitcnt lgkmcnt(4)
    ds_read_b64_tr_b16 v[180:181], v12 offset:512
    v_mfma_f32_16x16x32_bf16 v[88:91], v[204:207], v[160:163], v[88:91]
    ds_read_b64_tr_b16 v[182:183], v12 offset:1536
    v_mfma_f32_16x16x32_bf16 v[92:95], v[204:207], v[164:167], v[92:95]
    v_mfma_f32_16x16x32_bf16 v[24:27], v[204:207], v[144:147], v[24:27]
    v_mfma_f32_16x16x32_bf16 v[28:31], v[204:207], v[148:151], v[28:31]
    s_waitcnt lgkmcnt(4)
    ds_read_b64_tr_b16 v[184:185], v13 offset:512
    ds_read_b64_tr_b16 v[186:187], v13 offset:1536
    v_mfma_f32_16x16x32_bf16 v[96:99], v[208:211], v[160:163], v[96:99]
    ds_read_b128 v[168:171], v14 offset:17472
    v_mfma_f32_16x16x32_bf16 v[100:103], v[208:211], v[164:167], v[100:103]
    ds_read_b128 v[172:175], v14 offset:19648
    v_mfma_f32_16x16x32_bf16 v[32:35], v[208:211], v[144:147], v[32:35]
    v_mfma_f32_16x16x32_bf16 v[36:39], v[208:211], v[148:151], v[36:39]
    s_waitcnt lgkmcnt(6)
    ds_read_b64_tr_b16 v[188:189], v12 offset:768
    ds_read_b64_tr_b16 v[190:191], v12 offset:1792
    v_mfma_f32_16x16x32_bf16 v[104:107], v[176:179], v[160:163], v[104:107]
    ds_read_b128 v[152:155], v14 offset:64
    v_mfma_f32_16x16x32_bf16 v[108:111], v[176:179], v[164:167], v[108:111]
    ds_read_b128 v[156:159], v14 offset:2240
    v_mfma_f32_16x16x32_bf16 v[40:43], v[176:179], v[144:147], v[40:43]
    v_mfma_f32_16x16x32_bf16 v[44:47], v[176:179], v[148:151], v[44:47]
    s_waitcnt lgkmcnt(8)
    ds_read_b64_tr_b16 v[192:193], v13 offset:768
    v_mfma_f32_16x16x32_bf16 v[112:115], v[180:183], v[160:163], v[112:115]
    ds_read_b64_tr_b16 v[194:195], v13 offset:1792
    v_mfma_f32_16x16x32_bf16 v[116:119], v[180:183], v[164:167], v[116:119]
    v_mfma_f32_16x16x32_bf16 v[48:51], v[180:183], v[144:147], v[48:51]
    v_mfma_f32_16x16x32_bf16 v[52:55], v[180:183], v[148:151], v[52:55]
    s_waitcnt lgkmcnt(8)
    ds_read_b64_tr_b16 v[196:197], v12 offset:8192
    v_mfma_f32_16x16x32_bf16 v[120:123], v[184:187], v[160:163], v[120:123]
    ds_read_b64_tr_b16 v[198:199], v12 offset:9216
    v_mfma_f32_16x16x32_bf16 v[124:127], v[184:187], v[164:167], v[124:127]
    v_mfma_f32_16x16x32_bf16 v[56:59], v[184:187], v[144:147], v[56:59]
    v_mfma_f32_16x16x32_bf16 v[60:63], v[184:187], v[148:151], v[60:63]
    s_waitcnt lgkmcnt(6)
    ds_read_b64_tr_b16 v[200:201], v13 offset:8192
    v_mfma_f32_16x16x32_bf16 v[128:131], v[188:191], v[160:163], v[128:131]
    ds_read_b64_tr_b16 v[202:203], v13 offset:9216
    v_mfma_f32_16x16x32_bf16 v[132:135], v[188:191], v[164:167], v[132:135]
    v_mfma_f32_16x16x32_bf16 v[64:67], v[188:191], v[144:147], v[64:67]
    v_mfma_f32_16x16x32_bf16 v[68:71], v[188:191], v[148:151], v[68:71]
    s_waitcnt lgkmcnt(4)
    ds_read_b64_tr_b16 v[204:205], v12 offset:8448
    v_mfma_f32_16x16x32_bf16 v[136:139], v[192:195], v[160:163], v[136:139]
    ds_read_b64_tr_b16 v[206:207], v12 offset:9472
    v_mfma_f32_16x16x32_bf16 v[140:143], v[192:195], v[164:167], v[140:143]
    v_mfma_f32_16x16x32_bf16 v[72:75], v[192:195], v[144:147], v[72:75]
    v_mfma_f32_16x16x32_bf16 v[76:79], v[192:195], v[148:151], v[76:79]
    s_waitcnt lgkmcnt(4)
    ds_read_b64_tr_b16 v[208:209], v13 offset:8448
    v_mfma_f32_16x16x32_bf16 v[80:83], v[196:199], v[168:171], v[80:83]
    ds_read_b64_tr_b16 v[210:211], v13 offset:9472
    v_mfma_f32_16x16x32_bf16 v[84:87], v[196:199], v[172:175], v[84:87]
    v_mfma_f32_16x16x32_bf16 v[16:19], v[196:199], v[152:155], v[16:19]
    v_mfma_f32_16x16x32_bf16 v[20:23], v[196:199], v[156:159], v[20:23]
    s_waitcnt lgkmcnt(4)
    ds_read_b64_tr_b16 v[176:177], v12 offset:8704
    v_mfma_f32_16x16x32_bf16 v[88:91], v[200:203], v[168:171], v[88:91]
    ds_read_b64_tr_b16 v[178:179], v12 offset:9728
    v_mfma_f32_16x16x32_bf16 v[92:95], v[200:203], v[172:175], v[92:95]
    v_mfma_f32_16x16x32_bf16 v[24:27], v[200:203], v[152:155], v[24:27]
    v_mfma_f32_16x16x32_bf16 v[28:31], v[200:203], v[156:159], v[28:31]
    s_waitcnt lgkmcnt(4)
    ds_read_b64_tr_b16 v[180:181], v13 offset:8704
    v_mfma_f32_16x16x32_bf16 v[96:99], v[204:207], v[168:171], v[96:99]
    ds_read_b64_tr_b16 v[182:183], v13 offset:9728
    v_mfma_f32_16x16x32_bf16 v[100:103], v[204:207], v[172:175], v[100:103]
    v_mfma_f32_16x16x32_bf16 v[32:35], v[204:207], v[152:155], v[32:35]
    v_mfma_f32_16x16x32_bf16 v[36:39], v[204:207], v[156:159], v[36:39]
    s_waitcnt lgkmcnt(4)
    ds_read_b64_tr_b16 v[184:185], v12 offset:8960
    v_mfma_f32_16x16x32_bf16 v[104:107], v[208:211], v[168:171], v[104:107]
    ds_read_b64_tr_b16 v[186:187], v12 offset:9984
    v_mfma_f32_16x16x32_bf16 v[108:111], v[208:211], v[172:175], v[108:111]
    v_mfma_f32_16x16x32_bf16 v[40:43], v[208:211], v[152:155], v[40:43]
    v_mfma_f32_16x16x32_bf16 v[44:47], v[208:211], v[156:159], v[44:47]
    s_waitcnt lgkmcnt(4)
    ds_read_b64_tr_b16 v[188:189], v13 offset:8960
    v_mfma_f32_16x16x32_bf16 v[112:115], v[176:179], v[168:171], v[112:115]
    ds_read_b64_tr_b16 v[190:191], v13 offset:9984
    v_mfma_f32_16x16x32_bf16 v[116:119], v[176:179], v[172:175], v[116:119]
    v_mfma_f32_16x16x32_bf16 v[48:51], v[176:179], v[152:155], v[48:51]
    v_mfma_f32_16x16x32_bf16 v[52:55], v[176:179], v[156:159], v[52:55]
    s_waitcnt lgkmcnt(4)
    v_mfma_f32_16x16x32_bf16 v[120:123], v[180:183], v[168:171], v[120:123]
    v_mfma_f32_16x16x32_bf16 v[124:127], v[180:183], v[172:175], v[124:127]
    v_mfma_f32_16x16x32_bf16 v[56:59], v[180:183], v[152:155], v[56:59]
    v_mfma_f32_16x16x32_bf16 v[60:63], v[180:183], v[156:159], v[60:63]
    s_waitcnt lgkmcnt(2)
    s_waitcnt lgkmcnt(0)
    s_barrier
    v_add_u32 v14, 0xfffeb000, v14
    v_add_u32 v12, 0x4000, v12
    v_add_u32 v13, 0x4000, v13
    ds_read_b128 v[160:163], v14 offset:17408
    ds_read_b128 v[164:167], v14 offset:19584
    v_mfma_f32_16x16x32_bf16 v[128:131], v[184:187], v[168:171], v[128:131]
    ds_read_b128 v[144:147], v14 offset:0
    ds_read_b128 v[148:151], v14 offset:2176
    v_mfma_f32_16x16x32_bf16 v[132:135], v[184:187], v[172:175], v[132:135]
    ds_read_b128 v[224:227], v14 offset:17472
    ds_read_b128 v[228:231], v14 offset:19648
    v_mfma_f32_16x16x32_bf16 v[64:67], v[184:187], v[152:155], v[64:67]
    ds_read_b128 v[216:219], v14 offset:64
    ds_read_b128 v[220:223], v14 offset:2240
    v_mfma_f32_16x16x32_bf16 v[68:71], v[184:187], v[156:159], v[68:71]
    ds_read_b64_tr_b16 v[192:193], v12 offset:0
    ds_read_b64_tr_b16 v[194:195], v12 offset:1024
    v_mfma_f32_16x16x32_bf16 v[136:139], v[188:191], v[168:171], v[136:139]
    ds_read_b64_tr_b16 v[196:197], v12 offset:8192
    ds_read_b64_tr_b16 v[198:199], v12 offset:9216
    v_mfma_f32_16x16x32_bf16 v[140:143], v[188:191], v[172:175], v[140:143]
    ds_read_b64_tr_b16 v[200:201], v13 offset:0
    v_mfma_f32_16x16x32_bf16 v[72:75], v[188:191], v[152:155], v[72:75]
    ds_read_b64_tr_b16 v[202:203], v13 offset:1024
    v_mfma_f32_16x16x32_bf16 v[76:79], v[188:191], v[156:159], v[76:79]
    s_waitcnt lgkmcnt(4)
    ds_read_b64_tr_b16 v[204:205], v13 offset:8192
    v_mfma_f32_16x16x32_bf16 v[80:83], v[192:195], v[160:163], v[80:83]
    ds_read_b64_tr_b16 v[206:207], v13 offset:9216
    v_mfma_f32_16x16x32_bf16 v[84:87], v[192:195], v[164:167], v[84:87]
    v_mfma_f32_16x16x32_bf16 v[16:19], v[192:195], v[144:147], v[16:19]
    v_mfma_f32_16x16x32_bf16 v[20:23], v[192:195], v[148:151], v[20:23]
    s_waitcnt lgkmcnt(4)
    ds_read_b64_tr_b16 v[208:209], v12 offset:256
    v_mfma_f32_16x16x32_bf16 v[80:83], v[196:199], v[224:227], v[80:83]
    ds_read_b64_tr_b16 v[210:211], v12 offset:1280
    v_mfma_f32_16x16x32_bf16 v[84:87], v[196:199], v[228:231], v[84:87]
    v_mfma_f32_16x16x32_bf16 v[16:19], v[196:199], v[216:219], v[16:19]
    v_mfma_f32_16x16x32_bf16 v[20:23], v[196:199], v[220:223], v[20:23]
    s_waitcnt lgkmcnt(4)
    ds_read_b64_tr_b16 v[176:177], v12 offset:8448
    v_mfma_f32_16x16x32_bf16 v[88:91], v[200:203], v[160:163], v[88:91]
    ds_read_b64_tr_b16 v[178:179], v12 offset:9472
    v_mfma_f32_16x16x32_bf16 v[92:95], v[200:203], v[164:167], v[92:95]
    v_mfma_f32_16x16x32_bf16 v[24:27], v[200:203], v[144:147], v[24:27]
    v_mfma_f32_16x16x32_bf16 v[28:31], v[200:203], v[148:151], v[28:31]
    s_waitcnt lgkmcnt(4)
    ds_read_b64_tr_b16 v[180:181], v13 offset:256
    v_mfma_f32_16x16x32_bf16 v[88:91], v[204:207], v[224:227], v[88:91]
    ds_read_b64_tr_b16 v[182:183], v13 offset:1280
    v_mfma_f32_16x16x32_bf16 v[92:95], v[204:207], v[228:231], v[92:95]
    v_mfma_f32_16x16x32_bf16 v[24:27], v[204:207], v[216:219], v[24:27]
    v_mfma_f32_16x16x32_bf16 v[28:31], v[204:207], v[220:223], v[28:31]
    s_waitcnt lgkmcnt(4)
    ds_read_b64_tr_b16 v[184:185], v13 offset:8448
    v_mfma_f32_16x16x32_bf16 v[96:99], v[208:211], v[160:163], v[96:99]
    ds_read_b64_tr_b16 v[186:187], v13 offset:9472
    v_mfma_f32_16x16x32_bf16 v[100:103], v[208:211], v[164:167], v[100:103]
    v_mfma_f32_16x16x32_bf16 v[32:35], v[208:211], v[144:147], v[32:35]
    v_mul_f32 v80, s90, v80
    v_mul_f32 v81, s90, v81
    v_mfma_f32_16x16x32_bf16 v[36:39], v[208:211], v[148:151], v[36:39]
    s_waitcnt lgkmcnt(4)
    ds_read_b64_tr_b16 v[188:189], v12 offset:512
    v_mul_f32 v82, s90, v82
    v_mfma_f32_16x16x32_bf16 v[96:99], v[176:179], v[224:227], v[96:99]
    ds_read_b64_tr_b16 v[190:191], v12 offset:1536
    v_mul_f32 v83, s90, v83
    v_mul_f32 v84, s90, v84
    v_mfma_f32_16x16x32_bf16 v[100:103], v[176:179], v[228:231], v[100:103]
    ds_read_b64_tr_b16 v[192:193], v12 offset:8704
    v_mul_f32 v85, s90, v85
    v_mul_f32 v86, s90, v86
    v_mfma_f32_16x16x32_bf16 v[32:35], v[176:179], v[216:219], v[32:35]
    ds_read_b64_tr_b16 v[194:195], v12 offset:9728
    v_mul_f32 v87, s90, v87
    v_mul_f32 v88, s90, v88
    v_mfma_f32_16x16x32_bf16 v[36:39], v[176:179], v[220:223], v[36:39]
    s_waitcnt lgkmcnt(6)
    ds_read_b64_tr_b16 v[196:197], v13 offset:512
    v_mul_f32 v89, s90, v89
    v_mfma_f32_16x16x32_bf16 v[104:107], v[180:183], v[160:163], v[104:107]
    ds_read_b64_tr_b16 v[198:199], v13 offset:1536
    v_mul_f32 v90, s90, v90
    v_mul_f32 v91, s90, v91
    v_mfma_f32_16x16x32_bf16 v[108:111], v[180:183], v[164:167], v[108:111]
    ds_read_b64_tr_b16 v[200:201], v13 offset:8704
    v_mul_f32 v92, s90, v92
    v_mul_f32 v93, s90, v93
    v_mfma_f32_16x16x32_bf16 v[40:43], v[180:183], v[144:147], v[40:43]
    ds_read_b64_tr_b16 v[202:203], v13 offset:9728
    v_mul_f32 v94, s90, v94
    v_mul_f32 v95, s90, v95
    v_mfma_f32_16x16x32_bf16 v[44:47], v[180:183], v[148:151], v[44:47]
    s_waitcnt lgkmcnt(8)
    ds_read_b64_tr_b16 v[204:205], v12 offset:768
    v_cvt_pk_bf16_f32 v80, v80, v81
    v_mfma_f32_16x16x32_bf16 v[104:107], v[184:187], v[224:227], v[104:107]
    ds_read_b64_tr_b16 v[206:207], v12 offset:1792
    v_cvt_pk_bf16_f32 v81, v82, v83
    v_cvt_pk_bf16_f32 v82, v88, v89
    v_mfma_f32_16x16x32_bf16 v[108:111], v[184:187], v[228:231], v[108:111]
    ds_read_b64_tr_b16 v[208:209], v12 offset:8960
    v_cvt_pk_bf16_f32 v83, v90, v91
    v_cvt_pk_bf16_f32 v84, v84, v85
    v_mfma_f32_16x16x32_bf16 v[40:43], v[184:187], v[216:219], v[40:43]
    ds_read_b64_tr_b16 v[210:211], v12 offset:9984
    v_cvt_pk_bf16_f32 v85, v86, v87
    v_cvt_pk_bf16_f32 v86, v92, v93
    v_mfma_f32_16x16x32_bf16 v[44:47], v[184:187], v[220:223], v[44:47]
    s_waitcnt lgkmcnt(10)
    ds_read_b64_tr_b16 v[176:177], v13 offset:768
    v_cvt_pk_bf16_f32 v87, v94, v95
    v_mfma_f32_16x16x32_bf16 v[112:115], v[188:191], v[160:163], v[112:115]
    ds_read_b64_tr_b16 v[178:179], v13 offset:1792
    ds_write_b64 v212, v[80:81] offset:0
    ds_write_b64 v212, v[82:83] offset:512
    v_mfma_f32_16x16x32_bf16 v[116:119], v[188:191], v[164:167], v[116:119]
    s_waitcnt lgkmcnt(12)
    ds_read_b64_tr_b16 v[180:181], v13 offset:8960
    ds_write_b64 v213, v[84:85] offset:17408
    ds_write_b64 v213, v[86:87] offset:17920
    v_mfma_f32_16x16x32_bf16 v[112:115], v[192:195], v[224:227], v[112:115]
    ds_read_b64_tr_b16 v[182:183], v13 offset:9984
    v_mul_f32 v96, s90, v96
    v_mul_f32 v97, s90, v97
    v_mul_f32 v98, s90, v98
    v_mfma_f32_16x16x32_bf16 v[116:119], v[192:195], v[228:231], v[116:119]
    s_waitcnt lgkmcnt(14)
    v_mul_f32 v99, s90, v99
    v_mul_f32 v100, s90, v100
    v_mul_f32 v101, s90, v101
    v_mfma_f32_16x16x32_bf16 v[120:123], v[196:199], v[160:163], v[120:123]
    v_mul_f32 v102, s90, v102
    v_mul_f32 v103, s90, v103
    v_mfma_f32_16x16x32_bf16 v[124:127], v[196:199], v[164:167], v[124:127]
    s_waitcnt lgkmcnt(12)
    v_mul_f32 v104, s90, v104
    v_mul_f32 v105, s90, v105
    v_mul_f32 v106, s90, v106
    v_mfma_f32_16x16x32_bf16 v[120:123], v[200:203], v[224:227], v[120:123]
    v_mul_f32 v107, s90, v107
    v_mul_f32 v108, s90, v108
    v_mul_f32 v109, s90, v109
    v_mfma_f32_16x16x32_bf16 v[124:127], v[200:203], v[228:231], v[124:127]
    s_waitcnt lgkmcnt(10)
    v_mul_f32 v110, s90, v110
    v_mul_f32 v111, s90, v111
    v_cvt_pk_bf16_f32 v96, v96, v97
    v_mfma_f32_16x16x32_bf16 v[128:131], v[204:207], v[160:163], v[128:131]
    v_cvt_pk_bf16_f32 v97, v98, v99
    v_cvt_pk_bf16_f32 v98, v104, v105
    v_cvt_pk_bf16_f32 v99, v106, v107
    v_mfma_f32_16x16x32_bf16 v[132:135], v[204:207], v[164:167], v[132:135]
    s_waitcnt lgkmcnt(8)
    v_cvt_pk_bf16_f32 v100, v100, v101
    v_cvt_pk_bf16_f32 v101, v102, v103
    v_mfma_f32_16x16x32_bf16 v[128:131], v[208:211], v[224:227], v[128:131]
    v_cvt_pk_bf16_f32 v102, v108, v109
    v_cvt_pk_bf16_f32 v103, v110, v111
    ds_write_b64 v212, v[96:97] offset:1024
    v_mfma_f32_16x16x32_bf16 v[132:135], v[208:211], v[228:231], v[132:135]
    s_waitcnt lgkmcnt(7)
    ds_write_b64 v212, v[98:99] offset:1536
    ds_write_b64 v213, v[100:101] offset:18432
    ds_write_b64 v213, v[102:103] offset:18944
    v_mfma_f32_16x16x32_bf16 v[136:139], v[176:179], v[160:163], v[136:139]
    v_mul_f32 v112, s90, v112
    v_mul_f32 v113, s90, v113
    v_mul_f32 v114, s90, v114
    v_mfma_f32_16x16x32_bf16 v[140:143], v[176:179], v[164:167], v[140:143]
    s_waitcnt lgkmcnt(4)
    v_mul_f32 v115, s90, v115
    v_mul_f32 v116, s90, v116
    v_mul_f32 v117, s90, v117
    v_mfma_f32_16x16x32_bf16 v[136:139], v[180:183], v[224:227], v[136:139]
    v_mul_f32 v118, s90, v118
    v_mul_f32 v119, s90, v119
    v_mul_f32 v120, s90, v120
    v_mfma_f32_16x16x32_bf16 v[140:143], v[180:183], v[228:231], v[140:143]
    v_mul_f32 v121, s90, v121
    v_mul_f32 v122, s90, v122
    v_mul_f32 v123, s90, v123
    v_mfma_f32_16x16x32_bf16 v[48:51], v[188:191], v[144:147], v[48:51]
    v_mul_f32 v124, s90, v124
    v_mul_f32 v125, s90, v125
    v_mul_f32 v126, s90, v126
    v_mul_f32 v127, s90, v127
    v_mfma_f32_16x16x32_bf16 v[52:55], v[188:191], v[148:151], v[52:55]
    v_cvt_pk_bf16_f32 v112, v112, v113
    v_cvt_pk_bf16_f32 v113, v114, v115
    v_cvt_pk_bf16_f32 v114, v120, v121
    v_mfma_f32_16x16x32_bf16 v[48:51], v[192:195], v[216:219], v[48:51]
    v_cvt_pk_bf16_f32 v115, v122, v123
    v_cvt_pk_bf16_f32 v116, v116, v117
    v_cvt_pk_bf16_f32 v117, v118, v119
    v_mfma_f32_16x16x32_bf16 v[52:55], v[192:195], v[220:223], v[52:55]
    v_cvt_pk_bf16_f32 v118, v124, v125
    v_cvt_pk_bf16_f32 v119, v126, v127
    ds_write_b64 v212, v[112:113] offset:2048
    v_mfma_f32_16x16x32_bf16 v[56:59], v[196:199], v[144:147], v[56:59]
    ds_write_b64 v212, v[114:115] offset:2560
    ds_write_b64 v213, v[116:117] offset:19456
    ds_write_b64 v213, v[118:119] offset:19968
    v_mfma_f32_16x16x32_bf16 v[60:63], v[196:199], v[148:151], v[60:63]
    v_mul_f32 v128, s90, v128
    v_mul_f32 v129, s90, v129
    v_mul_f32 v130, s90, v130
    v_mfma_f32_16x16x32_bf16 v[56:59], v[200:203], v[216:219], v[56:59]
    v_mul_f32 v131, s90, v131
    v_mul_f32 v132, s90, v132
    v_mul_f32 v133, s90, v133
    v_mfma_f32_16x16x32_bf16 v[60:63], v[200:203], v[220:223], v[60:63]
    v_mul_f32 v134, s90, v134
    v_mul_f32 v135, s90, v135
    v_mfma_f32_16x16x32_bf16 v[64:67], v[204:207], v[144:147], v[64:67]
    v_mul_f32 v136, s90, v136
    v_mul_f32 v137, s90, v137
    v_mul_f32 v138, s90, v138
    v_mfma_f32_16x16x32_bf16 v[68:71], v[204:207], v[148:151], v[68:71]
    v_mul_f32 v139, s90, v139
    v_mul_f32 v140, s90, v140
    v_mul_f32 v141, s90, v141
    v_mfma_f32_16x16x32_bf16 v[64:67], v[208:211], v[216:219], v[64:67]
    v_mul_f32 v142, s90, v142
    v_mul_f32 v143, s90, v143
    v_cvt_pk_bf16_f32 v128, v128, v129
    v_mfma_f32_16x16x32_bf16 v[68:71], v[208:211], v[220:223], v[68:71]
    v_cvt_pk_bf16_f32 v129, v130, v131
    v_cvt_pk_bf16_f32 v130, v136, v137
    v_cvt_pk_bf16_f32 v131, v138, v139
    v_mfma_f32_16x16x32_bf16 v[72:75], v[176:179], v[144:147], v[72:75]
    v_cvt_pk_bf16_f32 v132, v132, v133
    v_cvt_pk_bf16_f32 v133, v134, v135
    v_mfma_f32_16x16x32_bf16 v[76:79], v[176:179], v[148:151], v[76:79]
    v_cvt_pk_bf16_f32 v134, v140, v141
    v_cvt_pk_bf16_f32 v135, v142, v143
    ds_write_b64 v212, v[128:129] offset:3072
    v_mfma_f32_16x16x32_bf16 v[72:75], v[180:183], v[216:219], v[72:75]
    ds_write_b64 v212, v[130:131] offset:3584
    ds_write_b64 v213, v[132:133] offset:20480
    ds_write_b64 v213, v[134:135] offset:20992
    v_mfma_f32_16x16x32_bf16 v[76:79], v[180:183], v[220:223], v[76:79]
    s_waitcnt vmcnt(0) lgkmcnt(0)
    s_barrier
    v_mul_f32 v16, s90, v16
    v_mul_f32 v17, s90, v17
    v_mul_f32 v18, s90, v18
    v_mul_f32 v19, s90, v19
    v_mul_f32 v20, s90, v20
    v_mul_f32 v21, s90, v21
    v_mul_f32 v22, s90, v22
    v_mul_f32 v23, s90, v23
    v_mul_f32 v24, s90, v24
    v_mul_f32 v25, s90, v25
    v_mul_f32 v26, s90, v26
    v_mul_f32 v27, s90, v27
    v_mul_f32 v28, s90, v28
    v_mul_f32 v29, s90, v29
    v_mul_f32 v30, s90, v30
    v_mul_f32 v31, s90, v31
    v_cvt_pk_bf16_f32 v80, v16, v17
    v_cvt_pk_bf16_f32 v81, v18, v19
    v_cvt_pk_bf16_f32 v82, v24, v25
    v_cvt_pk_bf16_f32 v83, v26, v27
    v_cvt_pk_bf16_f32 v96, v20, v21
    v_cvt_pk_bf16_f32 v97, v22, v23
    v_cvt_pk_bf16_f32 v98, v28, v29
    v_cvt_pk_bf16_f32 v99, v30, v31
    v_permlane32_swap_b32 v80, v82
    v_permlane32_swap_b32 v81, v83
    v_permlane32_swap_b32 v96, v98
    v_permlane32_swap_b32 v97, v99
    v_permlane16_swap_b32 v80, v82
    v_permlane16_swap_b32 v81, v83
    v_permlane16_swap_b32 v96, v98
    v_permlane16_swap_b32 v97, v99
    v_mul_f32 v32, s90, v32
    v_mul_f32 v33, s90, v33
    v_mul_f32 v34, s90, v34
    v_mul_f32 v35, s90, v35
    v_mul_f32 v36, s90, v36
    v_mul_f32 v37, s90, v37
    v_mul_f32 v38, s90, v38
    v_mul_f32 v39, s90, v39
    v_mul_f32 v40, s90, v40
    v_mul_f32 v41, s90, v41
    v_mul_f32 v42, s90, v42
    v_mul_f32 v43, s90, v43
    v_mul_f32 v44, s90, v44
    v_mul_f32 v45, s90, v45
    v_mul_f32 v46, s90, v46
    v_mul_f32 v47, s90, v47
    v_cvt_pk_bf16_f32 v84, v32, v33
    v_cvt_pk_bf16_f32 v85, v34, v35
    v_cvt_pk_bf16_f32 v86, v40, v41
    v_cvt_pk_bf16_f32 v87, v42, v43
    v_cvt_pk_bf16_f32 v100, v36, v37
    v_cvt_pk_bf16_f32 v101, v38, v39
    v_cvt_pk_bf16_f32 v102, v44, v45
    v_cvt_pk_bf16_f32 v103, v46, v47
    v_permlane32_swap_b32 v84, v86
    v_permlane32_swap_b32 v85, v87
    v_permlane32_swap_b32 v100, v102
    v_permlane32_swap_b32 v101, v103
    v_permlane16_swap_b32 v84, v86
    v_permlane16_swap_b32 v85, v87
    v_permlane16_swap_b32 v100, v102
    v_permlane16_swap_b32 v101, v103
    v_mul_f32 v48, s90, v48
    v_mul_f32 v49, s90, v49
    v_mul_f32 v50, s90, v50
    v_mul_f32 v51, s90, v51
    v_mul_f32 v52, s90, v52
    v_mul_f32 v53, s90, v53
    v_mul_f32 v54, s90, v54
    v_mul_f32 v55, s90, v55
    v_mul_f32 v56, s90, v56
    v_mul_f32 v57, s90, v57
    v_mul_f32 v58, s90, v58
    v_mul_f32 v59, s90, v59
    v_mul_f32 v60, s90, v60
    v_mul_f32 v61, s90, v61
    v_mul_f32 v62, s90, v62
    v_mul_f32 v63, s90, v63
    v_cvt_pk_bf16_f32 v88, v48, v49
    v_cvt_pk_bf16_f32 v89, v50, v51
    v_cvt_pk_bf16_f32 v90, v56, v57
    v_cvt_pk_bf16_f32 v91, v58, v59
    v_cvt_pk_bf16_f32 v104, v52, v53
    v_cvt_pk_bf16_f32 v105, v54, v55
    v_cvt_pk_bf16_f32 v106, v60, v61
    v_cvt_pk_bf16_f32 v107, v62, v63
    v_permlane32_swap_b32 v88, v90
    v_permlane32_swap_b32 v89, v91
    v_permlane32_swap_b32 v104, v106
    v_permlane32_swap_b32 v105, v107
    v_permlane16_swap_b32 v88, v90
    v_permlane16_swap_b32 v89, v91
    v_permlane16_swap_b32 v104, v106
    v_permlane16_swap_b32 v105, v107
    v_mul_f32 v64, s90, v64
    v_mul_f32 v65, s90, v65
    v_mul_f32 v66, s90, v66
    v_mul_f32 v67, s90, v67
    v_mul_f32 v68, s90, v68
    v_mul_f32 v69, s90, v69
    v_mul_f32 v70, s90, v70
    v_mul_f32 v71, s90, v71
    v_mul_f32 v72, s90, v72
    v_mul_f32 v73, s90, v73
    v_mul_f32 v74, s90, v74
    v_mul_f32 v75, s90, v75
    v_mul_f32 v76, s90, v76
    v_mul_f32 v77, s90, v77
    v_mul_f32 v78, s90, v78
    v_mul_f32 v79, s90, v79
    v_cvt_pk_bf16_f32 v92, v64, v65
    v_cvt_pk_bf16_f32 v93, v66, v67
    v_cvt_pk_bf16_f32 v94, v72, v73
    v_cvt_pk_bf16_f32 v95, v74, v75
    v_cvt_pk_bf16_f32 v108, v68, v69
    v_cvt_pk_bf16_f32 v109, v70, v71
    v_cvt_pk_bf16_f32 v110, v76, v77
    v_cvt_pk_bf16_f32 v111, v78, v79
    v_permlane32_swap_b32 v92, v94
    v_permlane32_swap_b32 v93, v95
    v_permlane32_swap_b32 v108, v110
    v_permlane32_swap_b32 v109, v111
    v_permlane16_swap_b32 v92, v94
    v_permlane16_swap_b32 v93, v95
    v_permlane16_swap_b32 v108, v110
    v_permlane16_swap_b32 v109, v111
L_attn:
    s_setprio 3
    s_lshl_b32 s63, s2, 14
    s_add_u32 s63, s63, s68
    s_add_u32 s63, s63, 17825792
    s_add_u32 s32, s18, s63
    s_addc_u32 s33, s19, 0
    s_mov_b32 s34, 2048
    s_mov_b32 s35, 0x00020000
    s_xor_b32 s63, s63, 16384
    s_add_u32 s20, s18, s63
    s_addc_u32 s21, s19, 0
    s_mov_b32 s22, 2048
    s_mov_b32 s23, 0x00020000
    v_mov_b32 v168, -1
    v_mov_b32 v172, 0x3f803f80
    v_mov_b32 v169, -1
    v_mov_b32 v173, 0x3f803f80
    v_mov_b32 v170, -1
    v_mov_b32 v174, 0x3f803f80
    v_mov_b32 v171, -1
    v_mov_b32 v175, 0x3f803f80
    ds_read_b128 v[176:179], v5 offset:52224
    ds_read_b128 v[180:183], v5 offset:52288
    ds_read_b128 v[184:187], v5 offset:52352
    ds_read_b128 v[188:191], v5 offset:52416
    ds_read_b128 v[192:195], v5 offset:56576
    ds_read_b128 v[196:199], v5 offset:56640
    ds_read_b128 v[200:203], v5 offset:56704
    s_waitcnt lgkmcnt(6)
    v_mfma_f32_16x16x32_bf16 v[112:115], v[176:179], v[80:83], 0
    v_mfma_f32_16x16x32_bf16 v[120:123], v[176:179], v[96:99], 0
    s_waitcnt lgkmcnt(5)
    ds_read_b128 v[204:207], v5 offset:56768
    v_mfma_f32_16x16x32_bf16 v[112:115], v[180:183], v[84:87], v[112:115]
    v_mfma_f32_16x16x32_bf16 v[120:123], v[180:183], v[100:103], v[120:123]
    s_waitcnt lgkmcnt(5)
    ds_read_b128 v[208:211], v5 offset:60928
    s_add_u32 m0, s65, 0
    s_add_u32 s72, s68, 32768
    buffer_load_dwordx4 v2, s[24:27], s72 offen offset:0 nt lds
    v_mfma_f32_16x16x32_bf16 v[112:115], v[184:187], v[88:91], v[112:115]
    v_mfma_f32_16x16x32_bf16 v[120:123], v[184:187], v[104:107], v[120:123]
    s_waitcnt lgkmcnt(5)
    ds_read_b128 v[176:179], v5 offset:60992
    v_mfma_f32_16x16x32_bf16 v[112:115], v[188:191], v[92:95], v[112:115]
    v_mfma_f32_16x16x32_bf16 v[120:123], v[188:191], v[108:111], v[120:123]
    s_waitcnt lgkmcnt(5)
    ds_read_b128 v[180:183], v5 offset:61056
    v_mfma_f32_16x16x32_bf16 v[116:119], v[192:195], v[80:83], 0
    v_mfma_f32_16x16x32_bf16 v[124:127], v[192:195], v[96:99], 0
    s_waitcnt lgkmcnt(5)
    ds_read_b128 v[184:187], v5 offset:61120
    v_mfma_f32_16x16x32_bf16 v[116:119], v[196:199], v[84:87], v[116:119]
    v_mfma_f32_16x16x32_bf16 v[124:127], v[196:199], v[100:103], v[124:127]
    s_waitcnt lgkmcnt(5)
    ds_read_b128 v[188:191], v5 offset:65280
    v_mfma_f32_16x16x32_bf16 v[116:119], v[200:203], v[88:91], v[116:119]
    v_mfma_f32_16x16x32_bf16 v[124:127], v[200:203], v[104:107], v[124:127]
    s_waitcnt lgkmcnt(5)
    ds_read_b128 v[192:195], v5 offset:65344
    s_add_u32 m0, s65, 64
    s_add_u32 s72, s68, 32768
    buffer_load_dwordx4 v2, s[24:27], s72 offen offset:1024 nt lds
    v_mfma_f32_16x16x32_bf16 v[116:119], v[204:207], v[92:95], v[116:119]
    v_mfma_f32_16x16x32_bf16 v[124:127], v[204:207], v[108:111], v[124:127]
    s_waitcnt lgkmcnt(5)
    ds_read_b128 v[196:199], v5 offset:65408
    v_mfma_f32_16x16x32_bf16 v[128:131], v[208:211], v[80:83], 0
    v_mfma_f32_16x16x32_bf16 v[136:139], v[208:211], v[96:99], 0
    s_waitcnt lgkmcnt(5)
    ds_read_b128 v[200:203], v5 offset:65472
    v_mfma_f32_16x16x32_bf16 v[128:131], v[176:179], v[84:87], v[128:131]
    v_max3_f32 v251, v112, v113, v114
    v_max3_f32 v252, v120, v121, v122
    v_max3_f32 v251, v251, v115, v116
    v_max3_f32 v252, v252, v123, v124
    v_max3_f32 v251, v251, v117, v118
    v_max3_f32 v252, v252, v125, v126
    v_mfma_f32_16x16x32_bf16 v[136:139], v[176:179], v[100:103], v[136:139]
    s_waitcnt lgkmcnt(5)
    v_max_f32 v251, v251, v119
    v_max_f32 v252, v252, v127
    v_mov_b32 v232, v251
    v_mov_b32 v233, v252
    s_nop 0
    v_permlane32_swap_b32 v251, v232
    v_permlane32_swap_b32 v252, v233
    v_mfma_f32_16x16x32_bf16 v[128:131], v[180:183], v[88:91], v[128:131]
    v_max_f32 v251, v251, v232
    v_max_f32 v252, v252, v233
    v_mov_b32 v232, v251
    v_mov_b32 v233, v252
    s_nop 0
    v_permlane16_swap_b32 v251, v232
    v_permlane16_swap_b32 v252, v233
    v_max_f32 v251, v251, v232
    v_mfma_f32_16x16x32_bf16 v[136:139], v[180:183], v[104:107], v[136:139]
    s_waitcnt lgkmcnt(4)
    v_max_f32 v252, v252, v233
    v_add_f32 v251, s74, v251
    v_add_f32 v252, s74, v252
    v_max_f32 v252, s88, v252
    v_sub_f32 v112, v112, v251
    v_sub_f32 v113, v113, v251
    v_mfma_f32_16x16x32_bf16 v[128:131], v[184:187], v[92:95], v[128:131]
    v_sub_f32 v114, v114, v251
    v_sub_f32 v115, v115, v251
    v_sub_f32 v116, v116, v251
    v_sub_f32 v117, v117, v251
    v_sub_f32 v118, v118, v251
    v_sub_f32 v119, v119, v251
    v_mfma_f32_16x16x32_bf16 v[136:139], v[184:187], v[108:111], v[136:139]
    s_waitcnt lgkmcnt(3)
    s_waitcnt vmcnt(6) lgkmcnt(0)
    s_barrier
    ds_read_b64_tr_b16 v[204:205], v6 offset:0
    ds_read_b64_tr_b16 v[206:207], v6 offset:4096
    v_sub_f32 v120, v120, v252
    v_sub_f32 v121, v121, v252
    v_sub_f32 v122, v122, v252
    v_sub_f32 v123, v123, v252
    v_sub_f32 v124, v124, v252
    v_sub_f32 v125, v125, v252
    s_add_u32 m0, s68, 102400
    s_add_u32 s73, s68, 32768
    buffer_load_dwordx4 v3, s[28:31], s73 offen offset:0 nt lds
    v_mfma_f32_16x16x32_bf16 v[132:135], v[188:191], v[80:83], 0
    ds_read_b64_tr_b16 v[208:209], v7 offset:0
    v_sub_f32 v126, v126, v252
    v_sub_f32 v127, v127, v252
    v_exp_f32 v212, v112
    v_exp_f32 v213, v113
    v_mfma_f32_16x16x32_bf16 v[140:143], v[188:191], v[96:99], 0
    ds_read_b64_tr_b16 v[210:211], v7 offset:4096
    ds_read_b64_tr_b16 v[176:177], v6 offset:256
    v_exp_f32 v214, v114
    v_exp_f32 v215, v115
    v_cvt_pk_bf16_f32 v144, v212, v213
    v_exp_f32 v212, v116
    v_mfma_f32_16x16x32_bf16 v[132:135], v[192:195], v[84:87], v[132:135]
    ds_read_b64_tr_b16 v[178:179], v6 offset:4352
    v_exp_f32 v213, v117
    v_cvt_pk_bf16_f32 v145, v214, v215
    v_exp_f32 v214, v118
    v_mfma_f32_16x16x32_bf16 v[140:143], v[192:195], v[100:103], v[140:143]
    ds_read_b64_tr_b16 v[180:181], v7 offset:256
    ds_read_b64_tr_b16 v[182:183], v7 offset:4352
    v_exp_f32 v215, v119
    v_cvt_pk_bf16_f32 v146, v212, v213
    v_exp_f32 v212, v120
    v_exp_f32 v213, v121
    v_mfma_f32_16x16x32_bf16 v[132:135], v[196:199], v[88:91], v[132:135]
    v_cvt_pk_bf16_f32 v147, v214, v215
    v_exp_f32 v214, v122
    v_exp_f32 v215, v123
    v_cvt_pk_bf16_f32 v148, v212, v213
    v_mfma_f32_16x16x32_bf16 v[140:143], v[196:199], v[104:107], v[140:143]
    ds_read_b128 v[184:187], v5 offset:34816
    ds_read_b128 v[188:191], v5 offset:34880
    v_exp_f32 v212, v124
    v_exp_f32 v213, v125
    v_cvt_pk_bf16_f32 v149, v214, v215
    v_exp_f32 v214, v126
    v_mfma_f32_16x16x32_bf16 v[132:135], v[200:203], v[92:95], v[132:135]
    v_exp_f32 v215, v127
    v_cvt_pk_bf16_f32 v150, v212, v213
    v_cvt_pk_bf16_f32 v151, v214, v215
    v_sub_f32 v160, 0, v251
    v_sub_f32 v161, 0, v251
    v_mfma_f32_16x16x32_bf16 v[140:143], v[200:203], v[108:111], v[140:143]
    s_waitcnt lgkmcnt(8)
    ds_read_b128 v[192:195], v5 offset:34944
    v_sub_f32 v162, 0, v251
    v_sub_f32 v163, 0, v251
    v_sub_f32 v164, 0, v252
    v_sub_f32 v165, 0, v252
    v_sub_f32 v166, 0, v252
    v_sub_f32 v167, 0, v252
    v_mfma_f32_16x16x32_bf16 v[16:19], v[204:207], v[144:147], 0
    v_mfma_f32_16x16x32_bf16 v[20:23], v[204:207], v[148:151], 0
    s_waitcnt lgkmcnt(7)
    ds_read_b128 v[196:199], v5 offset:35008
    s_add_u32 m0, s68, 102400
    s_add_u32 s73, s68, 32768
    buffer_load_dwordx4 v4, s[28:31], s73 offen offset:1024 nt lds
    v_mfma_f32_16x16x32_bf16 v[24:27], v[208:211], v[144:147], 0
    v_sub_f32 v128, v128, v251
    v_sub_f32 v129, v129, v251
    v_mfma_f32_16x16x32_bf16 v[28:31], v[208:211], v[148:151], 0
    s_waitcnt lgkmcnt(6)
    ds_read_b128 v[200:203], v5 offset:39168
    v_sub_f32 v130, v130, v251
    v_sub_f32 v131, v131, v251
    v_mfma_f32_16x16x32_bf16 v[32:35], v[176:179], v[144:147], 0
    v_sub_f32 v132, v132, v251
    v_sub_f32 v133, v133, v251
    v_mfma_f32_16x16x32_bf16 v[36:39], v[176:179], v[148:151], 0
    s_waitcnt lgkmcnt(5)
    ds_read_b128 v[204:207], v5 offset:39232
    v_sub_f32 v134, v134, v251
    v_mfma_f32_16x16x32_bf16 v[40:43], v[180:183], v[144:147], 0
    v_sub_f32 v135, v135, v251
    v_sub_f32 v136, v136, v252
    v_mfma_f32_16x16x32_bf16 v[44:47], v[180:183], v[148:151], 0
    s_waitcnt lgkmcnt(5)
    ds_read_b128 v[208:211], v5 offset:39296
    v_sub_f32 v137, v137, v252
    v_sub_f32 v138, v138, v252
    v_mfma_f32_16x16x32_bf16 v[112:115], v[184:187], v[80:83], v[160:163]
    v_sub_f32 v139, v139, v252
    v_sub_f32 v140, v140, v252
    v_mfma_f32_16x16x32_bf16 v[120:123], v[184:187], v[96:99], v[164:167]
    s_waitcnt lgkmcnt(5)
    ds_read_b128 v[176:179], v5 offset:39360
    v_sub_f32 v141, v141, v252
    v_sub_f32 v142, v142, v252
    v_mfma_f32_16x16x32_bf16 v[112:115], v[188:191], v[84:87], v[112:115]
    v_sub_f32 v143, v143, v252
    v_mfma_f32_16x16x32_bf16 v[120:123], v[188:191], v[100:103], v[120:123]
    s_waitcnt lgkmcnt(5)
    ds_read_b64_tr_b16 v[180:181], v6 offset:512
    ds_read_b64_tr_b16 v[182:183], v6 offset:4608
    v_exp_f32 v212, v128
    s_add_u32 m0, s65, 17408
    s_add_u32 s72, s68, 49152
    buffer_load_dwordx4 v2, s[24:27], s72 offen offset:0 nt lds
    v_mfma_f32_16x16x32_bf16 v[112:115], v[192:195], v[88:91], v[112:115]
    v_exp_f32 v213, v129
    v_mfma_f32_16x16x32_bf16 v[120:123], v[192:195], v[104:107], v[120:123]
    s_waitcnt lgkmcnt(6)
    ds_read_b64_tr_b16 v[184:185], v7 offset:512
    ds_read_b64_tr_b16 v[186:187], v7 offset:4608
    v_exp_f32 v214, v130
    v_mfma_f32_16x16x32_bf16 v[112:115], v[196:199], v[92:95], v[112:115]
    v_exp_f32 v215, v131
    v_mfma_f32_16x16x32_bf16 v[120:123], v[196:199], v[108:111], v[120:123]
    s_waitcnt lgkmcnt(7)
    ds_read_b64_tr_b16 v[188:189], v6 offset:768
    ds_read_b64_tr_b16 v[190:191], v6 offset:4864
    v_cvt_pk_bf16_f32 v152, v212, v213
    v_exp_f32 v212, v132
    v_mfma_f32_16x16x32_bf16 v[116:119], v[200:203], v[80:83], v[160:163]
    v_exp_f32 v213, v133
    v_mfma_f32_16x16x32_bf16 v[124:127], v[200:203], v[96:99], v[164:167]
    s_waitcnt lgkmcnt(8)
    ds_read_b64_tr_b16 v[192:193], v7 offset:768
    ds_read_b64_tr_b16 v[194:195], v7 offset:4864
    v_cvt_pk_bf16_f32 v153, v214, v215
    v_mfma_f32_16x16x32_bf16 v[116:119], v[204:207], v[84:87], v[116:119]
    v_exp_f32 v214, v134
    v_mfma_f32_16x16x32_bf16 v[124:127], v[204:207], v[100:103], v[124:127]
    s_waitcnt lgkmcnt(9)
    v_exp_f32 v215, v135
    v_mfma_f32_16x16x32_bf16 v[116:119], v[208:211], v[88:91], v[116:119]
    v_cvt_pk_bf16_f32 v154, v212, v213
    v_mfma_f32_16x16x32_bf16 v[124:127], v[208:211], v[104:107], v[124:127]
    s_waitcnt lgkmcnt(8)
    ds_read_b64_tr_b16 v[200:201], v6 offset:8192
    ds_read_b64_tr_b16 v[202:203], v6 offset:12288
    v_exp_f32 v212, v136
    s_add_u32 m0, s65, 17472
    s_add_u32 s72, s68, 49152
    buffer_load_dwordx4 v2, s[24:27], s72 offen offset:1024 nt lds
    v_mfma_f32_16x16x32_bf16 v[116:119], v[176:179], v[92:95], v[116:119]
    v_exp_f32 v213, v137
    v_mfma_f32_16x16x32_bf16 v[124:127], v[176:179], v[108:111], v[124:127]
    s_waitcnt lgkmcnt(8)
    ds_read_b64_tr_b16 v[204:205], v7 offset:8192
    ds_read_b64_tr_b16 v[206:207], v7 offset:12288
    v_cvt_pk_bf16_f32 v155, v214, v215
    v_exp_f32 v214, v138
    v_mfma_f32_16x16x32_bf16 v[48:51], v[180:183], v[144:147], 0
    v_exp_f32 v215, v139
    v_mfma_f32_16x16x32_bf16 v[52:55], v[180:183], v[148:151], 0
    s_waitcnt lgkmcnt(8)
    ds_read_b64_tr_b16 v[208:209], v6 offset:8448
    ds_read_b64_tr_b16 v[210:211], v6 offset:12544
    v_cvt_pk_bf16_f32 v156, v212, v213
    v_mfma_f32_16x16x32_bf16 v[56:59], v[184:187], v[144:147], 0
    v_exp_f32 v212, v140
    v_mfma_f32_16x16x32_bf16 v[60:63], v[184:187], v[148:151], 0
    s_waitcnt lgkmcnt(8)
    ds_read_b64_tr_b16 v[176:177], v7 offset:8448
    ds_read_b64_tr_b16 v[178:179], v7 offset:12544
    v_exp_f32 v213, v141
    v_mfma_f32_16x16x32_bf16 v[64:67], v[188:191], v[144:147], 0
    v_cvt_pk_bf16_f32 v157, v214, v215
    v_mfma_f32_16x16x32_bf16 v[68:71], v[188:191], v[148:151], 0
    s_waitcnt lgkmcnt(8)
    ds_read_b128 v[180:183], v5 offset:43520
    v_exp_f32 v214, v142
    v_mfma_f32_16x16x32_bf16 v[72:75], v[192:195], v[144:147], 0
    v_exp_f32 v215, v143
    v_mfma_f32_16x16x32_bf16 v[76:79], v[192:195], v[148:151], 0
    ds_read_b128 v[184:187], v5 offset:43584
    v_cvt_pk_bf16_f32 v158, v212, v213
    v_cvt_pk_bf16_f32 v159, v214, v215
    buffer_store_dwordx4 v[168:171], v236, s[32:35], 0 offen offset:0 sc1
    v_mfma_f32_16x16x32_bf16 v[216:219], v[172:175], v[144:147], 0
    v_or3_b32 v15, v152, v153, v154
    v_or3_b32 v15, v15, v155, v156
    v_mfma_f32_16x16x32_bf16 v[220:223], v[172:175], v[148:151], 0
    s_waitcnt lgkmcnt(8)
    ds_read_b128 v[188:191], v5 offset:43648
    v_or3_b32 v15, v15, v157, v158
    v_or_b32 v15, v15, v159
    v_and_b32 v15, 0x40004000, v15
    v_cmp_ne_u32 vcc, 0, v15
    s_cbranch_vccnz L_rare_1
L_back_1:
    v_mfma_f32_16x16x32_bf16 v[16:19], v[200:203], v[152:155], v[16:19]
    v_exp_f32 v212, v112
    v_mfma_f32_16x16x32_bf16 v[20:23], v[200:203], v[156:159], v[20:23]
    s_waitcnt lgkmcnt(7)
    ds_read_b128 v[192:195], v5 offset:43712
    v_mfma_f32_16x16x32_bf16 v[24:27], v[204:207], v[152:155], v[24:27]
    v_exp_f32 v213, v113
    v_mfma_f32_16x16x32_bf16 v[28:31], v[204:207], v[156:159], v[28:31]
    s_waitcnt lgkmcnt(6)
    ds_read_b128 v[196:199], v5 offset:47872
    v_cvt_pk_bf16_f32 v144, v212, v213
    v_mfma_f32_16x16x32_bf16 v[32:35], v[208:211], v[152:155], v[32:35]
    v_exp_f32 v214, v114
    v_mfma_f32_16x16x32_bf16 v[36:39], v[208:211], v[156:159], v[36:39]
    s_waitcnt lgkmcnt(5)
    ds_read_b128 v[200:203], v5 offset:47936
    v_mfma_f32_16x16x32_bf16 v[40:43], v[176:179], v[152:155], v[40:43]
    v_exp_f32 v215, v115
    v_mfma_f32_16x16x32_bf16 v[44:47], v[176:179], v[156:159], v[44:47]
    s_waitcnt lgkmcnt(5)
    ds_read_b128 v[204:207], v5 offset:48000
    v_cvt_pk_bf16_f32 v145, v214, v215
    buffer_store_dwordx4 v[168:171], v236, s[32:35], 0 offen offset:1024 sc1
    v_mfma_f32_16x16x32_bf16 v[128:131], v[180:183], v[80:83], v[160:163]
    v_exp_f32 v212, v116
    v_mfma_f32_16x16x32_bf16 v[136:139], v[180:183], v[96:99], v[164:167]
    s_waitcnt lgkmcnt(5)
    ds_read_b128 v[208:211], v5 offset:48064
    v_mfma_f32_16x16x32_bf16 v[128:131], v[184:187], v[84:87], v[128:131]
    v_exp_f32 v213, v117
    v_mfma_f32_16x16x32_bf16 v[136:139], v[184:187], v[100:103], v[136:139]
    s_waitcnt lgkmcnt(5)
    ds_read_b64_tr_b16 v[176:177], v6 offset:8704
    ds_read_b64_tr_b16 v[178:179], v6 offset:12800
    v_cvt_pk_bf16_f32 v146, v212, v213
    v_mfma_f32_16x16x32_bf16 v[128:131], v[188:191], v[88:91], v[128:131]
    v_exp_f32 v214, v118
    v_mfma_f32_16x16x32_bf16 v[136:139], v[188:191], v[104:107], v[136:139]
    s_waitcnt lgkmcnt(6)
    ds_read_b64_tr_b16 v[180:181], v7 offset:8704
    ds_read_b64_tr_b16 v[182:183], v7 offset:12800
    v_or3_b32 v15, v144, v145, v146
    v_mfma_f32_16x16x32_bf16 v[128:131], v[192:195], v[92:95], v[128:131]
    v_exp_f32 v215, v119
    v_mfma_f32_16x16x32_bf16 v[136:139], v[192:195], v[108:111], v[136:139]
    s_waitcnt lgkmcnt(7)
    ds_read_b64_tr_b16 v[184:185], v6 offset:8960
    ds_read_b64_tr_b16 v[186:187], v6 offset:13056
    v_cvt_pk_bf16_f32 v147, v214, v215
    v_mfma_f32_16x16x32_bf16 v[132:135], v[196:199], v[80:83], v[160:163]
    v_exp_f32 v212, v120
    v_mfma_f32_16x16x32_bf16 v[140:143], v[196:199], v[96:99], v[164:167]
    s_waitcnt lgkmcnt(8)
    ds_read_b64_tr_b16 v[188:189], v7 offset:8960
    ds_read_b64_tr_b16 v[190:191], v7 offset:13056
    v_mfma_f32_16x16x32_bf16 v[132:135], v[200:203], v[84:87], v[132:135]
    v_exp_f32 v213, v121
    v_mfma_f32_16x16x32_bf16 v[140:143], v[200:203], v[100:103], v[140:143]
    s_waitcnt lgkmcnt(9)
    v_cvt_pk_bf16_f32 v148, v212, v213
    v_mfma_f32_16x16x32_bf16 v[132:135], v[204:207], v[88:91], v[132:135]
    v_exp_f32 v214, v122
    v_mfma_f32_16x16x32_bf16 v[140:143], v[204:207], v[104:107], v[140:143]
    s_waitcnt lgkmcnt(8)
    v_or3_b32 v15, v15, v147, v148
    v_mfma_f32_16x16x32_bf16 v[132:135], v[208:211], v[92:95], v[132:135]
    v_exp_f32 v215, v123
    v_mfma_f32_16x16x32_bf16 v[140:143], v[208:211], v[108:111], v[140:143]
    s_waitcnt lgkmcnt(6)
    v_cvt_pk_bf16_f32 v149, v214, v215
    v_mfma_f32_16x16x32_bf16 v[48:51], v[176:179], v[152:155], v[48:51]
    v_exp_f32 v212, v124
    v_mfma_f32_16x16x32_bf16 v[52:55], v[176:179], v[156:159], v[52:55]
    s_waitcnt lgkmcnt(4)
    s_waitcnt vmcnt(6) lgkmcnt(0)
    s_barrier
    ds_read_b64_tr_b16 v[196:197], v6 offset:16384
    ds_read_b64_tr_b16 v[198:199], v6 offset:20480
    v_mfma_f32_16x16x32_bf16 v[56:59], v[180:183], v[152:155], v[56:59]
    ds_read_b64_tr_b16 v[200:201], v7 offset:16384
    v_exp_f32 v213, v125
    v_mfma_f32_16x16x32_bf16 v[60:63], v[180:183], v[156:159], v[60:63]
    ds_read_b64_tr_b16 v[202:203], v7 offset:20480
    ds_read_b64_tr_b16 v[204:205], v6 offset:16640
    v_cvt_pk_bf16_f32 v150, v212, v213
    s_add_u32 m0, s68, 118784
    s_add_u32 s73, s68, 49152
    buffer_load_dwordx4 v3, s[28:31], s73 offen offset:0 nt lds
    v_mfma_f32_16x16x32_bf16 v[64:67], v[184:187], v[152:155], v[64:67]
    ds_read_b64_tr_b16 v[206:207], v6 offset:20736
    v_exp_f32 v214, v126
    v_mfma_f32_16x16x32_bf16 v[68:71], v[184:187], v[156:159], v[68:71]
    ds_read_b64_tr_b16 v[208:209], v7 offset:16640
    ds_read_b64_tr_b16 v[210:211], v7 offset:20736
    v_or3_b32 v15, v15, v149, v150
    v_mfma_f32_16x16x32_bf16 v[72:75], v[188:191], v[152:155], v[72:75]
    v_exp_f32 v215, v127
    v_mfma_f32_16x16x32_bf16 v[76:79], v[188:191], v[156:159], v[76:79]
    ds_read_b128 v[176:179], v5 offset:0
    ds_read_b128 v[180:183], v5 offset:64
    v_cvt_pk_bf16_f32 v151, v214, v215
    v_mfma_f32_16x16x32_bf16 v[216:219], v[172:175], v[152:155], v[216:219]
    v_or_b32 v15, v15, v151
    v_mfma_f32_16x16x32_bf16 v[220:223], v[172:175], v[156:159], v[220:223]
    s_waitcnt lgkmcnt(8)
    ds_read_b128 v[184:187], v5 offset:128
    v_and_b32 v15, 0x40004000, v15
    v_cmp_ne_u32 vcc, 0, v15
    s_cbranch_vccnz L_rare_2
L_back_2:
    v_mfma_f32_16x16x32_bf16 v[16:19], v[196:199], v[144:147], v[16:19]
    v_exp_f32 v212, v128
    v_mfma_f32_16x16x32_bf16 v[20:23], v[196:199], v[148:151], v[20:23]
    s_waitcnt lgkmcnt(7)
    ds_read_b128 v[188:191], v5 offset:192
    v_mfma_f32_16x16x32_bf16 v[24:27], v[200:203], v[144:147], v[24:27]
    v_exp_f32 v213, v129
    v_mfma_f32_16x16x32_bf16 v[28:31], v[200:203], v[148:151], v[28:31]
    s_waitcnt lgkmcnt(6)
    ds_read_b128 v[192:195], v5 offset:4352
    v_cvt_pk_bf16_f32 v152, v212, v213
    s_add_u32 m0, s68, 118784
    s_add_u32 s73, s68, 49152
    buffer_load_dwordx4 v4, s[28:31], s73 offen offset:1024 nt lds
    v_mfma_f32_16x16x32_bf16 v[32:35], v[204:207], v[144:147], v[32:35]
    v_exp_f32 v214, v130
    v_mfma_f32_16x16x32_bf16 v[36:39], v[204:207], v[148:151], v[36:39]
    s_waitcnt lgkmcnt(5)
    ds_read_b128 v[196:199], v5 offset:4416
    v_mfma_f32_16x16x32_bf16 v[40:43], v[208:211], v[144:147], v[40:43]
    v_exp_f32 v215, v131
    v_mfma_f32_16x16x32_bf16 v[44:47], v[208:211], v[148:151], v[44:47]
    s_waitcnt lgkmcnt(5)
    ds_read_b128 v[200:203], v5 offset:4480
    v_cvt_pk_bf16_f32 v153, v214, v215
    v_mfma_f32_16x16x32_bf16 v[112:115], v[176:179], v[80:83], v[160:163]
    v_exp_f32 v212, v132
    v_mfma_f32_16x16x32_bf16 v[120:123], v[176:179], v[96:99], v[164:167]
    s_waitcnt lgkmcnt(5)
    ds_read_b128 v[204:207], v5 offset:4544
    v_mfma_f32_16x16x32_bf16 v[112:115], v[180:183], v[84:87], v[112:115]
    v_exp_f32 v213, v133
    v_mfma_f32_16x16x32_bf16 v[120:123], v[180:183], v[100:103], v[120:123]
    s_waitcnt lgkmcnt(5)
    ds_read_b64_tr_b16 v[208:209], v6 offset:16896
    ds_read_b64_tr_b16 v[210:211], v6 offset:20992
    v_cvt_pk_bf16_f32 v154, v212, v213
    v_mfma_f32_16x16x32_bf16 v[112:115], v[184:187], v[88:91], v[112:115]
    v_exp_f32 v214, v134
    v_mfma_f32_16x16x32_bf16 v[120:123], v[184:187], v[104:107], v[120:123]
    s_waitcnt lgkmcnt(6)
    ds_read_b64_tr_b16 v[176:177], v7 offset:16896
    ds_read_b64_tr_b16 v[178:179], v7 offset:20992
    v_or3_b32 v15, v152, v153, v154
    s_add_u32 m0, s65, 52224
    s_add_u32 s72, s68, 65536
    buffer_load_dwordx4 v2, s[24:27], s72 offen offset:0 nt lds
    v_mfma_f32_16x16x32_bf16 v[112:115], v[188:191], v[92:95], v[112:115]
    v_exp_f32 v215, v135
    v_mfma_f32_16x16x32_bf16 v[120:123], v[188:191], v[108:111], v[120:123]
    s_waitcnt lgkmcnt(7)
    ds_read_b64_tr_b16 v[180:181], v6 offset:17152
    ds_read_b64_tr_b16 v[182:183], v6 offset:21248
    v_cvt_pk_bf16_f32 v155, v214, v215
    v_mfma_f32_16x16x32_bf16 v[116:119], v[192:195], v[80:83], v[160:163]
    v_exp_f32 v212, v136
    v_mfma_f32_16x16x32_bf16 v[124:127], v[192:195], v[96:99], v[164:167]
    s_waitcnt lgkmcnt(8)
    ds_read_b64_tr_b16 v[184:185], v7 offset:17152
    ds_read_b64_tr_b16 v[186:187], v7 offset:21248
    v_mfma_f32_16x16x32_bf16 v[116:119], v[196:199], v[84:87], v[116:119]
    v_exp_f32 v213, v137
    v_mfma_f32_16x16x32_bf16 v[124:127], v[196:199], v[100:103], v[124:127]
    s_waitcnt lgkmcnt(9)
    v_cvt_pk_bf16_f32 v156, v212, v213
    v_mfma_f32_16x16x32_bf16 v[116:119], v[200:203], v[88:91], v[116:119]
    v_exp_f32 v214, v138
    v_mfma_f32_16x16x32_bf16 v[124:127], v[200:203], v[104:107], v[124:127]
    s_waitcnt lgkmcnt(8)
    ds_read_b64_tr_b16 v[192:193], v6 offset:24576
    ds_read_b64_tr_b16 v[194:195], v6 offset:28672
    v_or3_b32 v15, v15, v155, v156
    v_mfma_f32_16x16x32_bf16 v[116:119], v[204:207], v[92:95], v[116:119]
    v_exp_f32 v215, v139
    v_mfma_f32_16x16x32_bf16 v[124:127], v[204:207], v[108:111], v[124:127]
    s_waitcnt lgkmcnt(8)
    ds_read_b64_tr_b16 v[196:197], v7 offset:24576
    ds_read_b64_tr_b16 v[198:199], v7 offset:28672
    v_cvt_pk_bf16_f32 v157, v214, v215
    s_add_u32 m0, s65, 52288
    s_add_u32 s72, s68, 65536
    buffer_load_dwordx4 v2, s[24:27], s72 offen offset:1024 nt lds
    v_mfma_f32_16x16x32_bf16 v[48:51], v[208:211], v[144:147], v[48:51]
    v_exp_f32 v212, v140
    v_mfma_f32_16x16x32_bf16 v[52:55], v[208:211], v[148:151], v[52:55]
    s_waitcnt lgkmcnt(8)
    ds_read_b64_tr_b16 v[200:201], v6 offset:24832
    ds_read_b64_tr_b16 v[202:203], v6 offset:28928
    v_mfma_f32_16x16x32_bf16 v[56:59], v[176:179], v[144:147], v[56:59]
    v_exp_f32 v213, v141
    v_mfma_f32_16x16x32_bf16 v[60:63], v[176:179], v[148:151], v[60:63]
    s_waitcnt lgkmcnt(8)
    ds_read_b64_tr_b16 v[204:205], v7 offset:24832
    ds_read_b64_tr_b16 v[206:207], v7 offset:28928
    v_cvt_pk_bf16_f32 v158, v212, v213
    v_mfma_f32_16x16x32_bf16 v[64:67], v[180:183], v[144:147], v[64:67]
    v_exp_f32 v214, v142
    v_mfma_f32_16x16x32_bf16 v[68:71], v[180:183], v[148:151], v[68:71]
    s_waitcnt lgkmcnt(8)
    ds_read_b128 v[208:211], v5 offset:8704
    v_or3_b32 v15, v15, v157, v158
    v_mfma_f32_16x16x32_bf16 v[72:75], v[184:187], v[144:147], v[72:75]
    v_exp_f32 v215, v143
    v_mfma_f32_16x16x32_bf16 v[76:79], v[184:187], v[148:151], v[76:79]
    ds_read_b128 v[176:179], v5 offset:8768
    v_cvt_pk_bf16_f32 v159, v214, v215
    v_mfma_f32_16x16x32_bf16 v[216:219], v[172:175], v[144:147], v[216:219]
    v_or_b32 v15, v15, v159
    v_mfma_f32_16x16x32_bf16 v[220:223], v[172:175], v[148:151], v[220:223]
    s_waitcnt lgkmcnt(8)
    ds_read_b128 v[180:183], v5 offset:8832
    v_and_b32 v15, 0x40004000, v15
    v_cmp_ne_u32 vcc, 0, v15
    s_cbranch_vccnz L_rare_3
L_back_3:
    v_mfma_f32_16x16x32_bf16 v[16:19], v[192:195], v[152:155], v[16:19]
    v_exp_f32 v212, v112
    v_mfma_f32_16x16x32_bf16 v[20:23], v[192:195], v[156:159], v[20:23]
    s_waitcnt lgkmcnt(7)
    ds_read_b128 v[184:187], v5 offset:8896
    v_mfma_f32_16x16x32_bf16 v[24:27], v[196:199], v[152:155], v[24:27]
    v_exp_f32 v213, v113
    v_mfma_f32_16x16x32_bf16 v[28:31], v[196:199], v[156:159], v[28:31]
    s_waitcnt lgkmcnt(6)
    ds_read_b128 v[188:191], v5 offset:13056
    v_cvt_pk_bf16_f32 v144, v212, v213
    v_mfma_f32_16x16x32_bf16 v[32:35], v[200:203], v[152:155], v[32:35]
    v_exp_f32 v214, v114
    v_mfma_f32_16x16x32_bf16 v[36:39], v[200:203], v[156:159], v[36:39]
    s_waitcnt lgkmcnt(5)
    ds_read_b128 v[192:195], v5 offset:13120
    v_mfma_f32_16x16x32_bf16 v[40:43], v[204:207], v[152:155], v[40:43]
    v_exp_f32 v215, v115
    v_mfma_f32_16x16x32_bf16 v[44:47], v[204:207], v[156:159], v[44:47]
    s_waitcnt lgkmcnt(5)
    ds_read_b128 v[196:199], v5 offset:13184
    v_cvt_pk_bf16_f32 v145, v214, v215
    v_mfma_f32_16x16x32_bf16 v[128:131], v[208:211], v[80:83], v[160:163]
    v_exp_f32 v212, v116
    v_mfma_f32_16x16x32_bf16 v[136:139], v[208:211], v[96:99], v[164:167]
    s_waitcnt lgkmcnt(5)
    ds_read_b128 v[200:203], v5 offset:13248
    v_mfma_f32_16x16x32_bf16 v[128:131], v[176:179], v[84:87], v[128:131]
    v_exp_f32 v213, v117
    v_mfma_f32_16x16x32_bf16 v[136:139], v[176:179], v[100:103], v[136:139]
    s_waitcnt lgkmcnt(5)
    ds_read_b64_tr_b16 v[204:205], v6 offset:25088
    ds_read_b64_tr_b16 v[206:207], v6 offset:29184
    v_cvt_pk_bf16_f32 v146, v212, v213
    v_mfma_f32_16x16x32_bf16 v[128:131], v[180:183], v[88:91], v[128:131]
    v_exp_f32 v214, v118
    v_mfma_f32_16x16x32_bf16 v[136:139], v[180:183], v[104:107], v[136:139]
    s_waitcnt lgkmcnt(6)
    ds_read_b64_tr_b16 v[208:209], v7 offset:25088
    ds_read_b64_tr_b16 v[210:211], v7 offset:29184
    v_or3_b32 v15, v144, v145, v146
    v_mfma_f32_16x16x32_bf16 v[128:131], v[184:187], v[92:95], v[128:131]
    v_exp_f32 v215, v119
    v_mfma_f32_16x16x32_bf16 v[136:139], v[184:187], v[108:111], v[136:139]
    s_waitcnt lgkmcnt(7)
    ds_read_b64_tr_b16 v[176:177], v6 offset:25344
    ds_read_b64_tr_b16 v[178:179], v6 offset:29440
    v_cvt_pk_bf16_f32 v147, v214, v215
    v_mfma_f32_16x16x32_bf16 v[132:135], v[188:191], v[80:83], v[160:163]
    v_exp_f32 v212, v120
    v_mfma_f32_16x16x32_bf16 v[140:143], v[188:191], v[96:99], v[164:167]
    s_waitcnt lgkmcnt(8)
    ds_read_b64_tr_b16 v[180:181], v7 offset:25344
    ds_read_b64_tr_b16 v[182:183], v7 offset:29440
    v_mfma_f32_16x16x32_bf16 v[132:135], v[192:195], v[84:87], v[132:135]
    v_exp_f32 v213, v121
    v_mfma_f32_16x16x32_bf16 v[140:143], v[192:195], v[100:103], v[140:143]
    s_waitcnt lgkmcnt(9)
    v_cvt_pk_bf16_f32 v148, v212, v213
    v_mfma_f32_16x16x32_bf16 v[132:135], v[196:199], v[88:91], v[132:135]
    v_exp_f32 v214, v122
    v_mfma_f32_16x16x32_bf16 v[140:143], v[196:199], v[104:107], v[140:143]
    s_waitcnt lgkmcnt(8)
    v_or3_b32 v15, v15, v147, v148
    v_mfma_f32_16x16x32_bf16 v[132:135], v[200:203], v[92:95], v[132:135]
    v_exp_f32 v215, v123
    v_mfma_f32_16x16x32_bf16 v[140:143], v[200:203], v[108:111], v[140:143]
    s_waitcnt lgkmcnt(6)
    v_cvt_pk_bf16_f32 v149, v214, v215
    v_mfma_f32_16x16x32_bf16 v[48:51], v[204:207], v[152:155], v[48:51]
    v_exp_f32 v212, v124
    v_mfma_f32_16x16x32_bf16 v[52:55], v[204:207], v[156:159], v[52:55]
    s_waitcnt lgkmcnt(4)
    s_waitcnt vmcnt(4) lgkmcnt(0)
    s_barrier
    ds_read_b64_tr_b16 v[188:189], v6 offset:32768
    ds_read_b64_tr_b16 v[190:191], v6 offset:36864
    v_mfma_f32_16x16x32_bf16 v[56:59], v[208:211], v[152:155], v[56:59]
    ds_read_b64_tr_b16 v[192:193], v7 offset:32768
    v_exp_f32 v213, v125
    v_mfma_f32_16x16x32_bf16 v[60:63], v[208:211], v[156:159], v[60:63]
    ds_read_b64_tr_b16 v[194:195], v7 offset:36864
    ds_read_b64_tr_b16 v[196:197], v6 offset:33024
    v_cvt_pk_bf16_f32 v150, v212, v213
    v_mfma_f32_16x16x32_bf16 v[64:67], v[176:179], v[152:155], v[64:67]
    ds_read_b64_tr_b16 v[198:199], v6 offset:37120
    v_exp_f32 v214, v126
    v_mfma_f32_16x16x32_bf16 v[68:71], v[176:179], v[156:159], v[68:71]
    ds_read_b64_tr_b16 v[200:201], v7 offset:33024
    ds_read_b64_tr_b16 v[202:203], v7 offset:37120
    v_or3_b32 v15, v15, v149, v150
    s_add_u32 m0, s68, 69632
    s_add_u32 s73, s68, 65536
    buffer_load_dwordx4 v3, s[28:31], s73 offen offset:0 nt lds
    v_mfma_f32_16x16x32_bf16 v[72:75], v[180:183], v[152:155], v[72:75]
    v_exp_f32 v215, v127
    v_mfma_f32_16x16x32_bf16 v[76:79], v[180:183], v[156:159], v[76:79]
    ds_read_b128 v[204:207], v5 offset:17408
    ds_read_b128 v[208:211], v5 offset:17472
    v_cvt_pk_bf16_f32 v151, v214, v215
    v_mfma_f32_16x16x32_bf16 v[216:219], v[172:175], v[152:155], v[216:219]
    v_or_b32 v15, v15, v151
    v_mfma_f32_16x16x32_bf16 v[220:223], v[172:175], v[156:159], v[220:223]
    s_waitcnt lgkmcnt(8)
    ds_read_b128 v[176:179], v5 offset:17536
    v_and_b32 v15, 0x40004000, v15
    v_cmp_ne_u32 vcc, 0, v15
    s_cbranch_vccnz L_rare_4
L_back_4:
    v_mfma_f32_16x16x32_bf16 v[16:19], v[188:191], v[144:147], v[16:19]
    v_exp_f32 v212, v128
    v_mfma_f32_16x16x32_bf16 v[20:23], v[188:191], v[148:151], v[20:23]
    s_waitcnt lgkmcnt(7)
    ds_read_b128 v[180:183], v5 offset:17600
    v_mfma_f32_16x16x32_bf16 v[24:27], v[192:195], v[144:147], v[24:27]
    v_exp_f32 v213, v129
    v_mfma_f32_16x16x32_bf16 v[28:31], v[192:195], v[148:151], v[28:31]
    s_waitcnt lgkmcnt(6)
    ds_read_b128 v[184:187], v5 offset:21760
    v_cvt_pk_bf16_f32 v152, v212, v213
    v_mfma_f32_16x16x32_bf16 v[32:35], v[196:199], v[144:147], v[32:35]
    v_exp_f32 v214, v130
    v_mfma_f32_16x16x32_bf16 v[36:39], v[196:199], v[148:151], v[36:39]
    s_waitcnt lgkmcnt(5)
    ds_read_b128 v[188:191], v5 offset:21824
    s_add_u32 m0, s68, 69632
    s_add_u32 s73, s68, 65536
    buffer_load_dwordx4 v4, s[28:31], s73 offen offset:1024 nt lds
    v_mfma_f32_16x16x32_bf16 v[40:43], v[200:203], v[144:147], v[40:43]
    v_exp_f32 v215, v131
    v_mfma_f32_16x16x32_bf16 v[44:47], v[200:203], v[148:151], v[44:47]
    s_waitcnt lgkmcnt(5)
    ds_read_b128 v[192:195], v5 offset:21888
    v_cvt_pk_bf16_f32 v153, v214, v215
    v_mfma_f32_16x16x32_bf16 v[112:115], v[204:207], v[80:83], v[160:163]
    v_exp_f32 v212, v132
    v_mfma_f32_16x16x32_bf16 v[120:123], v[204:207], v[96:99], v[164:167]
    s_waitcnt lgkmcnt(5)
    ds_read_b128 v[196:199], v5 offset:21952
    v_mfma_f32_16x16x32_bf16 v[112:115], v[208:211], v[84:87], v[112:115]
    v_exp_f32 v213, v133
    v_mfma_f32_16x16x32_bf16 v[120:123], v[208:211], v[100:103], v[120:123]
    s_waitcnt lgkmcnt(5)
    ds_read_b64_tr_b16 v[200:201], v6 offset:33280
    ds_read_b64_tr_b16 v[202:203], v6 offset:37376
    v_cvt_pk_bf16_f32 v154, v212, v213
    v_mfma_f32_16x16x32_bf16 v[112:115], v[176:179], v[88:91], v[112:115]
    v_exp_f32 v214, v134
    v_mfma_f32_16x16x32_bf16 v[120:123], v[176:179], v[104:107], v[120:123]
    s_waitcnt lgkmcnt(6)
    ds_read_b64_tr_b16 v[204:205], v7 offset:33280
    ds_read_b64_tr_b16 v[206:207], v7 offset:37376
    v_or3_b32 v15, v152, v153, v154
    v_mfma_f32_16x16x32_bf16 v[112:115], v[180:183], v[92:95], v[112:115]
    v_exp_f32 v215, v135
    v_mfma_f32_16x16x32_bf16 v[120:123], v[180:183], v[108:111], v[120:123]
    s_waitcnt lgkmcnt(7)
    ds_read_b64_tr_b16 v[208:209], v6 offset:33536
    ds_read_b64_tr_b16 v[210:211], v6 offset:37632
    v_cvt_pk_bf16_f32 v155, v214, v215
    s_add_u32 m0, s65, 34816
    s_add_u32 s72, s68, 81920
    buffer_load_dwordx4 v2, s[24:27], s72 offen offset:0 nt lds
    v_mfma_f32_16x16x32_bf16 v[116:119], v[184:187], v[80:83], v[160:163]
    v_exp_f32 v212, v136
    v_mfma_f32_16x16x32_bf16 v[124:127], v[184:187], v[96:99], v[164:167]
    s_waitcnt lgkmcnt(8)
    ds_read_b64_tr_b16 v[176:177], v7 offset:33536
    ds_read_b64_tr_b16 v[178:179], v7 offset:37632
    v_mfma_f32_16x16x32_bf16 v[116:119], v[188:191], v[84:87], v[116:119]
    v_exp_f32 v213, v137
    v_mfma_f32_16x16x32_bf16 v[124:127], v[188:191], v[100:103], v[124:127]
    s_waitcnt lgkmcnt(9)
    v_cvt_pk_bf16_f32 v156, v212, v213
    v_mfma_f32_16x16x32_bf16 v[116:119], v[192:195], v[88:91], v[116:119]
    v_exp_f32 v214, v138
    v_mfma_f32_16x16x32_bf16 v[124:127], v[192:195], v[104:107], v[124:127]
    s_waitcnt lgkmcnt(8)
    ds_read_b64_tr_b16 v[184:185], v6 offset:40960
    ds_read_b64_tr_b16 v[186:187], v6 offset:45056
    v_or3_b32 v15, v15, v155, v156
    v_mfma_f32_16x16x32_bf16 v[116:119], v[196:199], v[92:95], v[116:119]
    v_exp_f32 v215, v139
    v_mfma_f32_16x16x32_bf16 v[124:127], v[196:199], v[108:111], v[124:127]
    s_waitcnt lgkmcnt(8)
    ds_read_b64_tr_b16 v[188:189], v7 offset:40960
    ds_read_b64_tr_b16 v[190:191], v7 offset:45056
    v_cvt_pk_bf16_f32 v157, v214, v215
    v_mfma_f32_16x16x32_bf16 v[48:51], v[200:203], v[144:147], v[48:51]
    v_exp_f32 v212, v140
    v_mfma_f32_16x16x32_bf16 v[52:55], v[200:203], v[148:151], v[52:55]
    s_waitcnt lgkmcnt(8)
    ds_read_b64_tr_b16 v[192:193], v6 offset:41216
    ds_read_b64_tr_b16 v[194:195], v6 offset:45312
    s_add_u32 m0, s65, 34880
    s_add_u32 s72, s68, 81920
    buffer_load_dwordx4 v2, s[24:27], s72 offen offset:1024 nt lds
    v_mfma_f32_16x16x32_bf16 v[56:59], v[204:207], v[144:147], v[56:59]
    v_exp_f32 v213, v141
    v_mfma_f32_16x16x32_bf16 v[60:63], v[204:207], v[148:151], v[60:63]
    s_waitcnt lgkmcnt(8)
    ds_read_b64_tr_b16 v[196:197], v7 offset:41216
    ds_read_b64_tr_b16 v[198:199], v7 offset:45312
    v_cvt_pk_bf16_f32 v158, v212, v213
    v_mfma_f32_16x16x32_bf16 v[64:67], v[208:211], v[144:147], v[64:67]
    v_exp_f32 v214, v142
    v_mfma_f32_16x16x32_bf16 v[68:71], v[208:211], v[148:151], v[68:71]
    s_waitcnt lgkmcnt(8)
    ds_read_b128 v[200:203], v5 offset:26112
    v_or3_b32 v15, v15, v157, v158
    v_mfma_f32_16x16x32_bf16 v[72:75], v[176:179], v[144:147], v[72:75]
    v_exp_f32 v215, v143
    v_mfma_f32_16x16x32_bf16 v[76:79], v[176:179], v[148:151], v[76:79]
    ds_read_b128 v[204:207], v5 offset:26176
    v_cvt_pk_bf16_f32 v159, v214, v215
    v_mfma_f32_16x16x32_bf16 v[216:219], v[172:175], v[144:147], v[216:219]
    v_or_b32 v15, v15, v159
    v_mfma_f32_16x16x32_bf16 v[220:223], v[172:175], v[148:151], v[220:223]
    s_waitcnt lgkmcnt(8)
    ds_read_b128 v[208:211], v5 offset:26240
    v_and_b32 v15, 0x40004000, v15
    v_cmp_ne_u32 vcc, 0, v15
    s_cbranch_vccnz L_rare_5
L_back_5:
    v_mfma_f32_16x16x32_bf16 v[16:19], v[184:187], v[152:155], v[16:19]
    v_exp_f32 v212, v112
    v_mfma_f32_16x16x32_bf16 v[20:23], v[184:187], v[156:159], v[20:23]
    s_waitcnt lgkmcnt(7)
    ds_read_b128 v[176:179], v5 offset:26304
    buffer_atomic_add v247, v245, s[48:51], 0 offen sc1
    v_mfma_f32_16x16x32_bf16 v[24:27], v[188:191], v[152:155], v[24:27]
    v_exp_f32 v213, v113
    v_mfma_f32_16x16x32_bf16 v[28:31], v[188:191], v[156:159], v[28:31]
    s_waitcnt lgkmcnt(6)
    ds_read_b128 v[180:183], v5 offset:30464
    v_cvt_pk_bf16_f32 v144, v212, v213
    v_mfma_f32_16x16x32_bf16 v[32:35], v[192:195], v[152:155], v[32:35]
    v_exp_f32 v214, v114
    v_mfma_f32_16x16x32_bf16 v[36:39], v[192:195], v[156:159], v[36:39]
    s_waitcnt lgkmcnt(5)
    ds_read_b128 v[184:187], v5 offset:30528
    v_mfma_f32_16x16x32_bf16 v[40:43], v[196:199], v[152:155], v[40:43]
    v_exp_f32 v215, v115
    v_mfma_f32_16x16x32_bf16 v[44:47], v[196:199], v[156:159], v[44:47]
    s_waitcnt lgkmcnt(5)
    ds_read_b128 v[188:191], v5 offset:30592
    v_cvt_pk_bf16_f32 v145, v214, v215
    v_mfma_f32_16x16x32_bf16 v[128:131], v[200:203], v[80:83], v[160:163]
    v_exp_f32 v212, v116
    v_mfma_f32_16x16x32_bf16 v[136:139], v[200:203], v[96:99], v[164:167]
    s_waitcnt lgkmcnt(5)
    ds_read_b128 v[192:195], v5 offset:30656
    v_mfma_f32_16x16x32_bf16 v[128:131], v[204:207], v[84:87], v[128:131]
    v_exp_f32 v213, v117
    v_mfma_f32_16x16x32_bf16 v[136:139], v[204:207], v[100:103], v[136:139]
    s_waitcnt lgkmcnt(5)
    ds_read_b64_tr_b16 v[196:197], v6 offset:41472
    ds_read_b64_tr_b16 v[198:199], v6 offset:45568
    v_cvt_pk_bf16_f32 v146, v212, v213
    v_mfma_f32_16x16x32_bf16 v[128:131], v[208:211], v[88:91], v[128:131]
    v_exp_f32 v214, v118
    v_mfma_f32_16x16x32_bf16 v[136:139], v[208:211], v[104:107], v[136:139]
    s_waitcnt lgkmcnt(6)
    ds_read_b64_tr_b16 v[200:201], v7 offset:41472
    ds_read_b64_tr_b16 v[202:203], v7 offset:45568
    v_or3_b32 v15, v144, v145, v146
    v_mfma_f32_16x16x32_bf16 v[128:131], v[176:179], v[92:95], v[128:131]
    v_exp_f32 v215, v119
    v_mfma_f32_16x16x32_bf16 v[136:139], v[176:179], v[108:111], v[136:139]
    s_waitcnt lgkmcnt(7)
    ds_read_b64_tr_b16 v[204:205], v6 offset:41728
    ds_read_b64_tr_b16 v[206:207], v6 offset:45824
    v_cvt_pk_bf16_f32 v147, v214, v215
    v_mfma_f32_16x16x32_bf16 v[132:135], v[180:183], v[80:83], v[160:163]
    v_exp_f32 v212, v120
    v_mfma_f32_16x16x32_bf16 v[140:143], v[180:183], v[96:99], v[164:167]
    s_waitcnt lgkmcnt(8)
    ds_read_b64_tr_b16 v[208:209], v7 offset:41728
    ds_read_b64_tr_b16 v[210:211], v7 offset:45824
    v_mfma_f32_16x16x32_bf16 v[132:135], v[184:187], v[84:87], v[132:135]
    v_exp_f32 v213, v121
    v_mfma_f32_16x16x32_bf16 v[140:143], v[184:187], v[100:103], v[140:143]
    s_waitcnt lgkmcnt(9)
    v_cvt_pk_bf16_f32 v148, v212, v213
    v_mfma_f32_16x16x32_bf16 v[132:135], v[188:191], v[88:91], v[132:135]
    v_exp_f32 v214, v122
    v_mfma_f32_16x16x32_bf16 v[140:143], v[188:191], v[104:107], v[140:143]
    s_waitcnt lgkmcnt(8)
    v_or3_b32 v15, v15, v147, v148
    v_mfma_f32_16x16x32_bf16 v[132:135], v[192:195], v[92:95], v[132:135]
    v_exp_f32 v215, v123
    v_mfma_f32_16x16x32_bf16 v[140:143], v[192:195], v[108:111], v[140:143]
    s_waitcnt lgkmcnt(6)
    v_cvt_pk_bf16_f32 v149, v214, v215
    v_mfma_f32_16x16x32_bf16 v[48:51], v[196:199], v[152:155], v[48:51]
    v_exp_f32 v212, v124
    v_mfma_f32_16x16x32_bf16 v[52:55], v[196:199], v[156:159], v[52:55]
    s_waitcnt lgkmcnt(4)
    s_waitcnt vmcnt(5) lgkmcnt(0)
    s_barrier
    ds_read_b64_tr_b16 v[180:181], v6 offset:49152
    ds_read_b64_tr_b16 v[182:183], v6 offset:53248
    v_mfma_f32_16x16x32_bf16 v[56:59], v[200:203], v[152:155], v[56:59]
    ds_read_b64_tr_b16 v[184:185], v7 offset:49152
    v_exp_f32 v213, v125
    v_mfma_f32_16x16x32_bf16 v[60:63], v[200:203], v[156:159], v[60:63]
    ds_read_b64_tr_b16 v[186:187], v7 offset:53248
    ds_read_b64_tr_b16 v[188:189], v6 offset:49408
    v_cvt_pk_bf16_f32 v150, v212, v213
    v_mfma_f32_16x16x32_bf16 v[64:67], v[204:207], v[152:155], v[64:67]
    ds_read_b64_tr_b16 v[190:191], v6 offset:53504
    v_exp_f32 v214, v126
    v_mfma_f32_16x16x32_bf16 v[68:71], v[204:207], v[156:159], v[68:71]
    ds_read_b64_tr_b16 v[192:193], v7 offset:49408
    ds_read_b64_tr_b16 v[194:195], v7 offset:53504
    v_or3_b32 v15, v15, v149, v150
    v_mfma_f32_16x16x32_bf16 v[72:75], v[208:211], v[152:155], v[72:75]
    v_exp_f32 v215, v127
    v_mfma_f32_16x16x32_bf16 v[76:79], v[208:211], v[156:159], v[76:79]
    ds_read_b128 v[196:199], v5 offset:52224
    ds_read_b128 v[200:203], v5 offset:52288
    v_cvt_pk_bf16_f32 v151, v214, v215
    s_add_u32 m0, s68, 86016
    s_add_u32 s73, s68, 81920
    buffer_load_dwordx4 v3, s[28:31], s73 offen offset:0 nt lds
    v_mfma_f32_16x16x32_bf16 v[216:219], v[172:175], v[152:155], v[216:219]
    v_or_b32 v15, v15, v151
    v_mfma_f32_16x16x32_bf16 v[220:223], v[172:175], v[156:159], v[220:223]
    s_waitcnt lgkmcnt(8)
    ds_read_b128 v[204:207], v5 offset:52352
    v_and_b32 v15, 0x40004000, v15
    v_cmp_ne_u32 vcc, 0, v15
    s_cbranch_vccnz L_rare_6
L_back_6:
    v_mfma_f32_16x16x32_bf16 v[16:19], v[180:183], v[144:147], v[16:19]
    v_exp_f32 v212, v128
    v_mfma_f32_16x16x32_bf16 v[20:23], v[180:183], v[148:151], v[20:23]
    s_waitcnt lgkmcnt(7)
    ds_read_b128 v[208:211], v5 offset:52416
    v_mfma_f32_16x16x32_bf16 v[24:27], v[184:187], v[144:147], v[24:27]
    v_exp_f32 v213, v129
    v_mfma_f32_16x16x32_bf16 v[28:31], v[184:187], v[148:151], v[28:31]
    s_waitcnt lgkmcnt(6)
    ds_read_b128 v[176:179], v5 offset:56576
    v_cvt_pk_bf16_f32 v152, v212, v213
    v_mfma_f32_16x16x32_bf16 v[32:35], v[188:191], v[144:147], v[32:35]
    v_exp_f32 v214, v130
    v_mfma_f32_16x16x32_bf16 v[36:39], v[188:191], v[148:151], v[36:39]
    s_waitcnt lgkmcnt(5)
    ds_read_b128 v[180:183], v5 offset:56640
    v_mfma_f32_16x16x32_bf16 v[40:43], v[192:195], v[144:147], v[40:43]
    v_exp_f32 v215, v131
    v_mfma_f32_16x16x32_bf16 v[44:47], v[192:195], v[148:151], v[44:47]
    s_waitcnt lgkmcnt(5)
    ds_read_b128 v[184:187], v5 offset:56704
    v_cvt_pk_bf16_f32 v153, v214, v215
    s_add_u32 m0, s68, 86016
    s_add_u32 s73, s68, 81920
    buffer_load_dwordx4 v4, s[28:31], s73 offen offset:1024 nt lds
    v_mfma_f32_16x16x32_bf16 v[112:115], v[196:199], v[80:83], v[160:163]
    v_exp_f32 v212, v132
    v_mfma_f32_16x16x32_bf16 v[120:123], v[196:199], v[96:99], v[164:167]
    s_waitcnt lgkmcnt(5)
    ds_read_b128 v[188:191], v5 offset:56768
    v_mfma_f32_16x16x32_bf16 v[112:115], v[200:203], v[84:87], v[112:115]
    v_exp_f32 v213, v133
    v_mfma_f32_16x16x32_bf16 v[120:123], v[200:203], v[100:103], v[120:123]
    s_waitcnt lgkmcnt(5)
    ds_read_b64_tr_b16 v[192:193], v6 offset:49664
    ds_read_b64_tr_b16 v[194:195], v6 offset:53760
    v_cvt_pk_bf16_f32 v154, v212, v213
    v_mfma_f32_16x16x32_bf16 v[112:115], v[204:207], v[88:91], v[112:115]
    v_exp_f32 v214, v134
    v_mfma_f32_16x16x32_bf16 v[120:123], v[204:207], v[104:107], v[120:123]
    s_waitcnt lgkmcnt(6)
    ds_read_b64_tr_b16 v[196:197], v7 offset:49664
    ds_read_b64_tr_b16 v[198:199], v7 offset:53760
    v_or3_b32 v15, v152, v153, v154
    v_mfma_f32_16x16x32_bf16 v[112:115], v[208:211], v[92:95], v[112:115]
    v_exp_f32 v215, v135
    v_mfma_f32_16x16x32_bf16 v[120:123], v[208:211], v[108:111], v[120:123]
    s_waitcnt lgkmcnt(7)
    ds_read_b64_tr_b16 v[200:201], v6 offset:49920
    ds_read_b64_tr_b16 v[202:203], v6 offset:54016
    v_cvt_pk_bf16_f32 v155, v214, v215
    v_mfma_f32_16x16x32_bf16 v[116:119], v[176:179], v[80:83], v[160:163]
    v_exp_f32 v212, v136
    v_mfma_f32_16x16x32_bf16 v[124:127], v[176:179], v[96:99], v[164:167]
    s_waitcnt lgkmcnt(8)
    ds_read_b64_tr_b16 v[204:205], v7 offset:49920
    ds_read_b64_tr_b16 v[206:207], v7 offset:54016
    s_add_u32 m0, s65, 0
    s_add_u32 s72, s68, 98304
    buffer_load_dwordx4 v2, s[24:27], s72 offen offset:0 nt lds
    v_mfma_f32_16x16x32_bf16 v[116:119], v[180:183], v[84:87], v[116:119]
    v_exp_f32 v213, v137
    v_mfma_f32_16x16x32_bf16 v[124:127], v[180:183], v[100:103], v[124:127]
    s_waitcnt lgkmcnt(9)
    v_cvt_pk_bf16_f32 v156, v212, v213
    v_mfma_f32_16x16x32_bf16 v[116:119], v[184:187], v[88:91], v[116:119]
    v_exp_f32 v214, v138
    v_mfma_f32_16x16x32_bf16 v[124:127], v[184:187], v[104:107], v[124:127]
    s_waitcnt lgkmcnt(8)
    ds_read_b64_tr_b16 v[176:177], v6 offset:57344
    ds_read_b64_tr_b16 v[178:179], v6 offset:61440
    v_or3_b32 v15, v15, v155, v156
    v_mfma_f32_16x16x32_bf16 v[116:119], v[188:191], v[92:95], v[116:119]
    v_exp_f32 v215, v139
    v_mfma_f32_16x16x32_bf16 v[124:127], v[188:191], v[108:111], v[124:127]
    s_waitcnt lgkmcnt(8)
    ds_read_b64_tr_b16 v[180:181], v7 offset:57344
    ds_read_b64_tr_b16 v[182:183], v7 offset:61440
    v_cvt_pk_bf16_f32 v157, v214, v215
    v_mfma_f32_16x16x32_bf16 v[48:51], v[192:195], v[144:147], v[48:51]
    v_exp_f32 v212, v140
    v_mfma_f32_16x16x32_bf16 v[52:55], v[192:195], v[148:151], v[52:55]
    s_waitcnt lgkmcnt(8)
    ds_read_b64_tr_b16 v[184:185], v6 offset:57600
    ds_read_b64_tr_b16 v[186:187], v6 offset:61696
    v_mfma_f32_16x16x32_bf16 v[56:59], v[196:199], v[144:147], v[56:59]
    v_exp_f32 v213, v141
    v_mfma_f32_16x16x32_bf16 v[60:63], v[196:199], v[148:151], v[60:63]
    s_waitcnt lgkmcnt(8)
    ds_read_b64_tr_b16 v[188:189], v7 offset:57600
    ds_read_b64_tr_b16 v[190:191], v7 offset:61696
    v_cvt_pk_bf16_f32 v158, v212, v213
    s_add_u32 m0, s65, 64
    s_add_u32 s72, s68, 98304
    buffer_load_dwordx4 v2, s[24:27], s72 offen offset:1024 nt lds
    v_mfma_f32_16x16x32_bf16 v[64:67], v[200:203], v[144:147], v[64:67]
    v_exp_f32 v214, v142
    v_mfma_f32_16x16x32_bf16 v[68:71], v[200:203], v[148:151], v[68:71]
    s_waitcnt lgkmcnt(8)
    ds_read_b128 v[192:195], v5 offset:60928
    v_or3_b32 v15, v15, v157, v158
    v_mfma_f32_16x16x32_bf16 v[72:75], v[204:207], v[144:147], v[72:75]
    v_exp_f32 v215, v143
    v_mfma_f32_16x16x32_bf16 v[76:79], v[204:207], v[148:151], v[76:79]
    ds_read_b128 v[196:199], v5 offset:60992
    v_cvt_pk_bf16_f32 v159, v214, v215
    v_mfma_f32_16x16x32_bf16 v[216:219], v[172:175], v[144:147], v[216:219]
    v_or_b32 v15, v15, v159
    v_mfma_f32_16x16x32_bf16 v[220:223], v[172:175], v[148:151], v[220:223]
    s_waitcnt lgkmcnt(8)
    ds_read_b128 v[200:203], v5 offset:61056
    v_and_b32 v15, 0x40004000, v15
    v_cmp_ne_u32 vcc, 0, v15
    s_cbranch_vccnz L_rare_7
L_back_7:
    v_mfma_f32_16x16x32_bf16 v[16:19], v[176:179], v[152:155], v[16:19]
    v_exp_f32 v212, v112
    v_mfma_f32_16x16x32_bf16 v[20:23], v[176:179], v[156:159], v[20:23]
    s_waitcnt lgkmcnt(7)
    ds_read_b128 v[204:207], v5 offset:61120
    v_mfma_f32_16x16x32_bf16 v[24:27], v[180:183], v[152:155], v[24:27]
    v_exp_f32 v213, v113
    v_mfma_f32_16x16x32_bf16 v[28:31], v[180:183], v[156:159], v[28:31]
    s_waitcnt lgkmcnt(6)
    ds_read_b128 v[208:211], v5 offset:65280
    v_cvt_pk_bf16_f32 v144, v212, v213
    s_add_u32 m0, s68, 135168
    s_add_u32 s72, s80, 0
    buffer_load_dwordx4 v237, s[40:43], s72 offen lds
    v_mfma_f32_16x16x32_bf16 v[32:35], v[184:187], v[152:155], v[32:35]
    v_exp_f32 v214, v114
    v_mfma_f32_16x16x32_bf16 v[36:39], v[184:187], v[156:159], v[36:39]
    s_waitcnt lgkmcnt(5)
    ds_read_b128 v[176:179], v5 offset:65344
    v_mfma_f32_16x16x32_bf16 v[40:43], v[188:191], v[152:155], v[40:43]
    v_exp_f32 v215, v115
    v_mfma_f32_16x16x32_bf16 v[44:47], v[188:191], v[156:159], v[44:47]
    s_waitcnt lgkmcnt(5)
    ds_read_b128 v[180:183], v5 offset:65408
    v_cvt_pk_bf16_f32 v145, v214, v215
    v_mfma_f32_16x16x32_bf16 v[128:131], v[192:195], v[80:83], v[160:163]
    v_exp_f32 v212, v116
    v_mfma_f32_16x16x32_bf16 v[136:139], v[192:195], v[96:99], v[164:167]
    s_waitcnt lgkmcnt(5)
    ds_read_b128 v[184:187], v5 offset:65472
    v_mfma_f32_16x16x32_bf16 v[128:131], v[196:199], v[84:87], v[128:131]
    v_exp_f32 v213, v117
    v_mfma_f32_16x16x32_bf16 v[136:139], v[196:199], v[100:103], v[136:139]
    s_waitcnt lgkmcnt(5)
    ds_read_b64_tr_b16 v[188:189], v6 offset:57856
    ds_read_b64_tr_b16 v[190:191], v6 offset:61952
    v_cvt_pk_bf16_f32 v146, v212, v213
    v_mfma_f32_16x16x32_bf16 v[128:131], v[200:203], v[88:91], v[128:131]
    v_exp_f32 v214, v118
    v_mfma_f32_16x16x32_bf16 v[136:139], v[200:203], v[104:107], v[136:139]
    s_waitcnt lgkmcnt(6)
    ds_read_b64_tr_b16 v[192:193], v7 offset:57856
    ds_read_b64_tr_b16 v[194:195], v7 offset:61952
    v_or3_b32 v15, v144, v145, v146
    s_add_u32 m0, s68, 136192
    s_add_u32 s72, s80, 0
    buffer_load_dwordx4 v238, s[40:43], s72 offen lds
    v_mfma_f32_16x16x32_bf16 v[128:131], v[204:207], v[92:95], v[128:131]
    v_exp_f32 v215, v119
    v_mfma_f32_16x16x32_bf16 v[136:139], v[204:207], v[108:111], v[136:139]
    s_waitcnt lgkmcnt(7)
    ds_read_b64_tr_b16 v[196:197], v6 offset:58112
    ds_read_b64_tr_b16 v[198:199], v6 offset:62208
    v_cvt_pk_bf16_f32 v147, v214, v215
    v_mfma_f32_16x16x32_bf16 v[132:135], v[208:211], v[80:83], v[160:163]
    v_exp_f32 v212, v120
    v_mfma_f32_16x16x32_bf16 v[140:143], v[208:211], v[96:99], v[164:167]
    s_waitcnt lgkmcnt(8)
    ds_read_b64_tr_b16 v[200:201], v7 offset:58112
    ds_read_b64_tr_b16 v[202:203], v7 offset:62208
    v_mfma_f32_16x16x32_bf16 v[132:135], v[176:179], v[84:87], v[132:135]
    v_exp_f32 v213, v121
    v_mfma_f32_16x16x32_bf16 v[140:143], v[176:179], v[100:103], v[140:143]
    s_waitcnt lgkmcnt(9)
    v_cvt_pk_bf16_f32 v148, v212, v213
    v_mfma_f32_16x16x32_bf16 v[132:135], v[180:183], v[88:91], v[132:135]
    v_exp_f32 v214, v122
    v_mfma_f32_16x16x32_bf16 v[140:143], v[180:183], v[104:107], v[140:143]
    s_waitcnt lgkmcnt(8)
    v_or3_b32 v15, v15, v147, v148
    v_mfma_f32_16x16x32_bf16 v[132:135], v[184:187], v[92:95], v[132:135]
    v_exp_f32 v215, v123
    v_mfma_f32_16x16x32_bf16 v[140:143], v[184:187], v[108:111], v[140:143]
    s_waitcnt lgkmcnt(6)
    v_cvt_pk_bf16_f32 v149, v214, v215
    v_mfma_f32_16x16x32_bf16 v[48:51], v[188:191], v[152:155], v[48:51]
    v_exp_f32 v212, v124
    v_mfma_f32_16x16x32_bf16 v[52:55], v[188:191], v[156:159], v[52:55]
    s_waitcnt lgkmcnt(4)
    s_waitcnt vmcnt(7) lgkmcnt(0)
    s_barrier
    ds_read_b64_tr_b16 v[208:209], v6 offset:0
    ds_read_b64_tr_b16 v[210:211], v6 offset:4096
    v_mfma_f32_16x16x32_bf16 v[56:59], v[192:195], v[152:155], v[56:59]
    ds_read_b64_tr_b16 v[176:177], v7 offset:0
    v_exp_f32 v213, v125
    v_mfma_f32_16x16x32_bf16 v[60:63], v[192:195], v[156:159], v[60:63]
    ds_read_b64_tr_b16 v[178:179], v7 offset:4096
    ds_read_b64_tr_b16 v[180:181], v6 offset:256
    v_cvt_pk_bf16_f32 v150, v212, v213
    v_mfma_f32_16x16x32_bf16 v[64:67], v[196:199], v[152:155], v[64:67]
    ds_read_b64_tr_b16 v[182:183], v6 offset:4352
    v_exp_f32 v214, v126
    v_mfma_f32_16x16x32_bf16 v[68:71], v[196:199], v[156:159], v[68:71]
    ds_read_b64_tr_b16 v[184:185], v7 offset:256
    ds_read_b64_tr_b16 v[186:187], v7 offset:4352
    v_or3_b32 v15, v15, v149, v150
    v_mfma_f32_16x16x32_bf16 v[72:75], v[200:203], v[152:155], v[72:75]
    v_exp_f32 v215, v127
    v_mfma_f32_16x16x32_bf16 v[76:79], v[200:203], v[156:159], v[76:79]
    ds_read_b128 v[188:191], v5 offset:34816
    ds_read_b128 v[192:195], v5 offset:34880
    v_cvt_pk_bf16_f32 v151, v214, v215
    v_mfma_f32_16x16x32_bf16 v[216:219], v[172:175], v[152:155], v[216:219]
    v_or_b32 v15, v15, v151
    v_mfma_f32_16x16x32_bf16 v[220:223], v[172:175], v[156:159], v[220:223]
    s_waitcnt lgkmcnt(8)
    ds_read_b128 v[196:199], v5 offset:34944
    v_and_b32 v15, 0x40004000, v15
    v_cmp_ne_u32 vcc, 0, v15
    s_cbranch_vccnz L_rare_8
L_back_8:
    s_add_u32 m0, s68, 102400
    s_add_u32 s73, s68, 98304
    buffer_load_dwordx4 v3, s[28:31], s73 offen offset:0 nt lds
    v_mfma_f32_16x16x32_bf16 v[16:19], v[208:211], v[144:147], v[16:19]
    v_exp_f32 v212, v128
    v_mfma_f32_16x16x32_bf16 v[20:23], v[208:211], v[148:151], v[20:23]
    s_waitcnt lgkmcnt(7)
    ds_read_b128 v[200:203], v5 offset:35008
    v_mfma_f32_16x16x32_bf16 v[24:27], v[176:179], v[144:147], v[24:27]
    v_exp_f32 v213, v129
    v_mfma_f32_16x16x32_bf16 v[28:31], v[176:179], v[148:151], v[28:31]
    s_waitcnt lgkmcnt(6)
    ds_read_b128 v[204:207], v5 offset:39168
    v_cvt_pk_bf16_f32 v152, v212, v213
    v_mfma_f32_16x16x32_bf16 v[32:35], v[180:183], v[144:147], v[32:35]
    v_exp_f32 v214, v130
    v_mfma_f32_16x16x32_bf16 v[36:39], v[180:183], v[148:151], v[36:39]
    s_waitcnt lgkmcnt(5)
    ds_read_b128 v[208:211], v5 offset:39232
    v_mfma_f32_16x16x32_bf16 v[40:43], v[184:187], v[144:147], v[40:43]
    v_exp_f32 v215, v131
    v_mfma_f32_16x16x32_bf16 v[44:47], v[184:187], v[148:151], v[44:47]
    s_waitcnt lgkmcnt(5)
    ds_read_b128 v[176:179], v5 offset:39296
    v_cvt_pk_bf16_f32 v153, v214, v215
    v_mfma_f32_16x16x32_bf16 v[112:115], v[188:191], v[80:83], v[160:163]
    v_exp_f32 v212, v132
    v_mfma_f32_16x16x32_bf16 v[120:123], v[188:191], v[96:99], v[164:167]
    s_waitcnt lgkmcnt(5)
    ds_read_b128 v[180:183], v5 offset:39360
    s_add_u32 m0, s68, 102400
    s_add_u32 s73, s68, 98304
    buffer_load_dwordx4 v4, s[28:31], s73 offen offset:1024 nt lds
    v_mfma_f32_16x16x32_bf16 v[112:115], v[192:195], v[84:87], v[112:115]
    v_exp_f32 v213, v133
    v_mfma_f32_16x16x32_bf16 v[120:123], v[192:195], v[100:103], v[120:123]
    s_waitcnt lgkmcnt(5)
    ds_read_b64_tr_b16 v[184:185], v6 offset:512
    ds_read_b64_tr_b16 v[186:187], v6 offset:4608
    v_cvt_pk_bf16_f32 v154, v212, v213
    v_mfma_f32_16x16x32_bf16 v[112:115], v[196:199], v[88:91], v[112:115]
    v_exp_f32 v214, v134
    v_mfma_f32_16x16x32_bf16 v[120:123], v[196:199], v[104:107], v[120:123]
    s_waitcnt lgkmcnt(6)
    ds_read_b64_tr_b16 v[188:189], v7 offset:512
    ds_read_b64_tr_b16 v[190:191], v7 offset:4608
    v_or3_b32 v15, v152, v153, v154
    v_mfma_f32_16x16x32_bf16 v[112:115], v[200:203], v[92:95], v[112:115]
    v_exp_f32 v215, v135
    v_mfma_f32_16x16x32_bf16 v[120:123], v[200:203], v[108:111], v[120:123]
    s_waitcnt lgkmcnt(7)
    ds_read_b64_tr_b16 v[192:193], v6 offset:768
    ds_read_b64_tr_b16 v[194:195], v6 offset:4864
    v_cvt_pk_bf16_f32 v155, v214, v215
    v_mfma_f32_16x16x32_bf16 v[116:119], v[204:207], v[80:83], v[160:163]
    v_exp_f32 v212, v136
    v_mfma_f32_16x16x32_bf16 v[124:127], v[204:207], v[96:99], v[164:167]
    s_waitcnt lgkmcnt(8)
    ds_read_b64_tr_b16 v[196:197], v7 offset:768
    ds_read_b64_tr_b16 v[198:199], v7 offset:4864
    v_mfma_f32_16x16x32_bf16 v[116:119], v[208:211], v[84:87], v[116:119]
    v_exp_f32 v213, v137
    v_mfma_f32_16x16x32_bf16 v[124:127], v[208:211], v[100:103], v[124:127]
    s_waitcnt lgkmcnt(9)
    v_cvt_pk_bf16_f32 v156, v212, v213
    s_add_u32 m0, s65, 17408
    s_add_u32 s72, s68, 114688
    buffer_load_dwordx4 v2, s[24:27], s72 offen offset:0 nt lds
    v_mfma_f32_16x16x32_bf16 v[116:119], v[176:179], v[88:91], v[116:119]
    v_exp_f32 v214, v138
    v_mfma_f32_16x16x32_bf16 v[124:127], v[176:179], v[104:107], v[124:127]
    s_waitcnt lgkmcnt(8)
    ds_read_b64_tr_b16 v[204:205], v6 offset:8192
    ds_read_b64_tr_b16 v[206:207], v6 offset:12288
    v_or3_b32 v15, v15, v155, v156
    v_mfma_f32_16x16x32_bf16 v[116:119], v[180:183], v[92:95], v[116:119]
    v_exp_f32 v215, v139
    v_mfma_f32_16x16x32_bf16 v[124:127], v[180:183], v[108:111], v[124:127]
    s_waitcnt lgkmcnt(8)
    ds_read_b64_tr_b16 v[208:209], v7 offset:8192
    ds_read_b64_tr_b16 v[210:211], v7 offset:12288
    v_cvt_pk_bf16_f32 v157, v214, v215
    v_mfma_f32_16x16x32_bf16 v[48:51], v[184:187], v[144:147], v[48:51]
    v_exp_f32 v212, v140
    v_mfma_f32_16x16x32_bf16 v[52:55], v[184:187], v[148:151], v[52:55]
    s_waitcnt lgkmcnt(8)
    ds_read_b64_tr_b16 v[176:177], v6 offset:8448
    ds_read_b64_tr_b16 v[178:179], v6 offset:12544
    v_mfma_f32_16x16x32_bf16 v[56:59], v[188:191], v[144:147], v[56:59]
    v_exp_f32 v213, v141
    v_mfma_f32_16x16x32_bf16 v[60:63], v[188:191], v[148:151], v[60:63]
    s_waitcnt lgkmcnt(8)
    ds_read_b64_tr_b16 v[180:181], v7 offset:8448
    ds_read_b64_tr_b16 v[182:183], v7 offset:12544
    v_cvt_pk_bf16_f32 v158, v212, v213
    v_mfma_f32_16x16x32_bf16 v[64:67], v[192:195], v[144:147], v[64:67]
    v_exp_f32 v214, v142
    v_mfma_f32_16x16x32_bf16 v[68:71], v[192:195], v[148:151], v[68:71]
    s_waitcnt lgkmcnt(8)
    ds_read_b128 v[184:187], v5 offset:43520
    v_or3_b32 v15, v15, v157, v158
    s_add_u32 m0, s65, 17472
    s_add_u32 s72, s68, 114688
    buffer_load_dwordx4 v2, s[24:27], s72 offen offset:1024 nt lds
    v_mfma_f32_16x16x32_bf16 v[72:75], v[196:199], v[144:147], v[72:75]
    v_exp_f32 v215, v143
    v_mfma_f32_16x16x32_bf16 v[76:79], v[196:199], v[148:151], v[76:79]
    ds_read_b128 v[188:191], v5 offset:43584
    v_cvt_pk_bf16_f32 v159, v214, v215
    v_mfma_f32_16x16x32_bf16 v[216:219], v[172:175], v[144:147], v[216:219]
    v_or_b32 v15, v15, v159
    v_mfma_f32_16x16x32_bf16 v[220:223], v[172:175], v[148:151], v[220:223]
    s_waitcnt lgkmcnt(8)
    ds_read_b128 v[192:195], v5 offset:43648
    v_and_b32 v15, 0x40004000, v15
    v_cmp_ne_u32 vcc, 0, v15
    s_cbranch_vccnz L_rare_9
L_back_9:
    v_mfma_f32_16x16x32_bf16 v[16:19], v[204:207], v[152:155], v[16:19]
    v_exp_f32 v212, v112
    v_mfma_f32_16x16x32_bf16 v[20:23], v[204:207], v[156:159], v[20:23]
    s_waitcnt lgkmcnt(7)
    ds_read_b128 v[196:199], v5 offset:43712
    v_mfma_f32_16x16x32_bf16 v[24:27], v[208:211], v[152:155], v[24:27]
    v_exp_f32 v213, v113
    v_mfma_f32_16x16x32_bf16 v[28:31], v[208:211], v[156:159], v[28:31]
    s_waitcnt lgkmcnt(6)
    ds_read_b128 v[200:203], v5 offset:47872
    v_cvt_pk_bf16_f32 v144, v212, v213
    v_mfma_f32_16x16x32_bf16 v[32:35], v[176:179], v[152:155], v[32:35]
    v_exp_f32 v214, v114
    v_mfma_f32_16x16x32_bf16 v[36:39], v[176:179], v[156:159], v[36:39]
    s_waitcnt lgkmcnt(5)
    ds_read_b128 v[204:207], v5 offset:47936
    v_mfma_f32_16x16x32_bf16 v[40:43], v[180:183], v[152:155], v[40:43]
    v_exp_f32 v215, v115
    v_mfma_f32_16x16x32_bf16 v[44:47], v[180:183], v[156:159], v[44:47]
    s_waitcnt lgkmcnt(5)
    ds_read_b128 v[208:211], v5 offset:48000
    v_cvt_pk_bf16_f32 v145, v214, v215
    v_mfma_f32_16x16x32_bf16 v[128:131], v[184:187], v[80:83], v[160:163]
    v_exp_f32 v212, v116
    v_mfma_f32_16x16x32_bf16 v[136:139], v[184:187], v[96:99], v[164:167]
    s_waitcnt lgkmcnt(5)
    ds_read_b128 v[176:179], v5 offset:48064
    v_mfma_f32_16x16x32_bf16 v[128:131], v[188:191], v[84:87], v[128:131]
    v_exp_f32 v213, v117
    v_mfma_f32_16x16x32_bf16 v[136:139], v[188:191], v[100:103], v[136:139]
    s_waitcnt lgkmcnt(5)
    ds_read_b64_tr_b16 v[180:181], v6 offset:8704
    ds_read_b64_tr_b16 v[182:183], v6 offset:12800
    v_cvt_pk_bf16_f32 v146, v212, v213
    v_mfma_f32_16x16x32_bf16 v[128:131], v[192:195], v[88:91], v[128:131]
    v_exp_f32 v214, v118
    v_mfma_f32_16x16x32_bf16 v[136:139], v[192:195], v[104:107], v[136:139]
    s_waitcnt lgkmcnt(6)
    ds_read_b64_tr_b16 v[184:185], v7 offset:8704
    ds_read_b64_tr_b16 v[186:187], v7 offset:12800
    v_or3_b32 v15, v144, v145, v146
    v_mfma_f32_16x16x32_bf16 v[128:131], v[196:199], v[92:95], v[128:131]
    v_exp_f32 v215, v119
    v_mfma_f32_16x16x32_bf16 v[136:139], v[196:199], v[108:111], v[136:139]
    s_waitcnt lgkmcnt(7)
    ds_read_b64_tr_b16 v[188:189], v6 offset:8960
    ds_read_b64_tr_b16 v[190:191], v6 offset:13056
    v_cvt_pk_bf16_f32 v147, v214, v215
    v_mfma_f32_16x16x32_bf16 v[132:135], v[200:203], v[80:83], v[160:163]
    v_exp_f32 v212, v120
    v_mfma_f32_16x16x32_bf16 v[140:143], v[200:203], v[96:99], v[164:167]
    s_waitcnt lgkmcnt(8)
    ds_read_b64_tr_b16 v[192:193], v7 offset:8960
    ds_read_b64_tr_b16 v[194:195], v7 offset:13056
    v_mfma_f32_16x16x32_bf16 v[132:135], v[204:207], v[84:87], v[132:135]
    v_exp_f32 v213, v121
    v_mfma_f32_16x16x32_bf16 v[140:143], v[204:207], v[100:103], v[140:143]
    s_waitcnt lgkmcnt(9)
    v_cvt_pk_bf16_f32 v148, v212, v213
    v_mfma_f32_16x16x32_bf16 v[132:135], v[208:211], v[88:91], v[132:135]
    v_exp_f32 v214, v122
    v_mfma_f32_16x16x32_bf16 v[140:143], v[208:211], v[104:107], v[140:143]
    s_waitcnt lgkmcnt(8)
    v_or3_b32 v15, v15, v147, v148
    v_mfma_f32_16x16x32_bf16 v[132:135], v[176:179], v[92:95], v[132:135]
    v_exp_f32 v215, v123
    v_mfma_f32_16x16x32_bf16 v[140:143], v[176:179], v[108:111], v[140:143]
    s_waitcnt lgkmcnt(6)
    v_cvt_pk_bf16_f32 v149, v214, v215
    v_mfma_f32_16x16x32_bf16 v[48:51], v[180:183], v[152:155], v[48:51]
    v_exp_f32 v212, v124
    v_mfma_f32_16x16x32_bf16 v[52:55], v[180:183], v[156:159], v[52:55]
    s_waitcnt lgkmcnt(4)
    s_waitcnt vmcnt(6) lgkmcnt(0)
    s_barrier
    ds_read_b64_tr_b16 v[200:201], v6 offset:16384
    ds_read_b64_tr_b16 v[202:203], v6 offset:20480
    s_add_u32 m0, s68, 118784
    s_add_u32 s73, s68, 114688
    buffer_load_dwordx4 v3, s[28:31], s73 offen offset:0 nt lds
    v_mfma_f32_16x16x32_bf16 v[56:59], v[184:187], v[152:155], v[56:59]
    ds_read_b64_tr_b16 v[204:205], v7 offset:16384
    v_exp_f32 v213, v125
    v_mfma_f32_16x16x32_bf16 v[60:63], v[184:187], v[156:159], v[60:63]
    ds_read_b64_tr_b16 v[206:207], v7 offset:20480
    ds_read_b64_tr_b16 v[208:209], v6 offset:16640
    v_cvt_pk_bf16_f32 v150, v212, v213
    v_mfma_f32_16x16x32_bf16 v[64:67], v[188:191], v[152:155], v[64:67]
    ds_read_b64_tr_b16 v[210:211], v6 offset:20736
    v_exp_f32 v214, v126
    v_mfma_f32_16x16x32_bf16 v[68:71], v[188:191], v[156:159], v[68:71]
    ds_read_b64_tr_b16 v[176:177], v7 offset:16640
    ds_read_b64_tr_b16 v[178:179], v7 offset:20736
    v_or3_b32 v15, v15, v149, v150
    v_mfma_f32_16x16x32_bf16 v[72:75], v[192:195], v[152:155], v[72:75]
    v_exp_f32 v215, v127
    v_mfma_f32_16x16x32_bf16 v[76:79], v[192:195], v[156:159], v[76:79]
    ds_read_b128 v[180:183], v5 offset:0
    ds_read_b128 v[184:187], v5 offset:64
    v_cvt_pk_bf16_f32 v151, v214, v215
    v_mfma_f32_16x16x32_bf16 v[216:219], v[172:175], v[152:155], v[216:219]
    v_or_b32 v15, v15, v151
    v_mfma_f32_16x16x32_bf16 v[220:223], v[172:175], v[156:159], v[220:223]
    s_waitcnt lgkmcnt(8)
    ds_read_b128 v[188:191], v5 offset:128
    v_and_b32 v15, 0x40004000, v15
    v_cmp_ne_u32 vcc, 0, v15
    s_cbranch_vccnz L_rare_10
L_back_10:
    v_mfma_f32_16x16x32_bf16 v[16:19], v[200:203], v[144:147], v[16:19]
    v_exp_f32 v212, v128
    v_mfma_f32_16x16x32_bf16 v[20:23], v[200:203], v[148:151], v[20:23]
    s_waitcnt lgkmcnt(7)
    ds_read_b128 v[192:195], v5 offset:192
    s_add_u32 m0, s68, 118784
    s_add_u32 s73, s68, 114688
    buffer_load_dwordx4 v4, s[28:31], s73 offen offset:1024 nt lds
    v_mfma_f32_16x16x32_bf16 v[24:27], v[204:207], v[144:147], v[24:27]
    v_exp_f32 v213, v129
    v_mfma_f32_16x16x32_bf16 v[28:31], v[204:207], v[148:151], v[28:31]
    s_waitcnt lgkmcnt(6)
    ds_read_b128 v[196:199], v5 offset:4352
    v_cvt_pk_bf16_f32 v152, v212, v213
    v_mfma_f32_16x16x32_bf16 v[32:35], v[208:211], v[144:147], v[32:35]
    v_exp_f32 v214, v130
    v_mfma_f32_16x16x32_bf16 v[36:39], v[208:211], v[148:151], v[36:39]
    s_waitcnt lgkmcnt(5)
    ds_read_b128 v[200:203], v5 offset:4416
    v_mfma_f32_16x16x32_bf16 v[40:43], v[176:179], v[144:147], v[40:43]
    v_exp_f32 v215, v131
    v_mfma_f32_16x16x32_bf16 v[44:47], v[176:179], v[148:151], v[44:47]
    s_waitcnt lgkmcnt(5)
    ds_read_b128 v[204:207], v5 offset:4480
    v_cvt_pk_bf16_f32 v153, v214, v215
    v_mfma_f32_16x16x32_bf16 v[112:115], v[180:183], v[80:83], v[160:163]
    v_exp_f32 v212, v132
    v_mfma_f32_16x16x32_bf16 v[120:123], v[180:183], v[96:99], v[164:167]
    s_waitcnt lgkmcnt(5)
    ds_read_b128 v[208:211], v5 offset:4544
    v_mfma_f32_16x16x32_bf16 v[112:115], v[184:187], v[84:87], v[112:115]
    v_exp_f32 v213, v133
    v_mfma_f32_16x16x32_bf16 v[120:123], v[184:187], v[100:103], v[120:123]
    s_waitcnt lgkmcnt(5)
    ds_read_b64_tr_b16 v[176:177], v6 offset:16896
    ds_read_b64_tr_b16 v[178:179], v6 offset:20992
    v_cvt_pk_bf16_f32 v154, v212, v213
    s_add_u32 m0, s68, 52224
    s_add_u32 s72, s80, 32768
    buffer_load_dwordx4 v237, s[40:43], s72 offen lds
    v_mfma_f32_16x16x32_bf16 v[112:115], v[188:191], v[88:91], v[112:115]
    v_exp_f32 v214, v134
    v_mfma_f32_16x16x32_bf16 v[120:123], v[188:191], v[104:107], v[120:123]
    s_waitcnt lgkmcnt(6)
    ds_read_b64_tr_b16 v[180:181], v7 offset:16896
    ds_read_b64_tr_b16 v[182:183], v7 offset:20992
    v_or3_b32 v15, v152, v153, v154
    v_mfma_f32_16x16x32_bf16 v[112:115], v[192:195], v[92:95], v[112:115]
    v_exp_f32 v215, v135
    v_mfma_f32_16x16x32_bf16 v[120:123], v[192:195], v[108:111], v[120:123]
    s_waitcnt lgkmcnt(7)
    ds_read_b64_tr_b16 v[184:185], v6 offset:17152
    ds_read_b64_tr_b16 v[186:187], v6 offset:21248
    v_cvt_pk_bf16_f32 v155, v214, v215
    v_mfma_f32_16x16x32_bf16 v[116:119], v[196:199], v[80:83], v[160:163]
    v_exp_f32 v212, v136
    v_mfma_f32_16x16x32_bf16 v[124:127], v[196:199], v[96:99], v[164:167]
    s_waitcnt lgkmcnt(8)
    ds_read_b64_tr_b16 v[188:189], v7 offset:17152
    ds_read_b64_tr_b16 v[190:191], v7 offset:21248
    v_mfma_f32_16x16x32_bf16 v[116:119], v[200:203], v[84:87], v[116:119]
    v_exp_f32 v213, v137
    v_mfma_f32_16x16x32_bf16 v[124:127], v[200:203], v[100:103], v[124:127]
    s_waitcnt lgkmcnt(9)
    v_cvt_pk_bf16_f32 v156, v212, v213
    v_mfma_f32_16x16x32_bf16 v[116:119], v[204:207], v[88:91], v[116:119]
    v_exp_f32 v214, v138
    v_mfma_f32_16x16x32_bf16 v[124:127], v[204:207], v[104:107], v[124:127]
    s_waitcnt lgkmcnt(8)
    ds_read_b64_tr_b16 v[196:197], v6 offset:24576
    ds_read_b64_tr_b16 v[198:199], v6 offset:28672
    v_or3_b32 v15, v15, v155, v156
    s_add_u32 m0, s68, 53248
    s_add_u32 s72, s80, 32768
    buffer_load_dwordx4 v238, s[40:43], s72 offen lds
    v_mfma_f32_16x16x32_bf16 v[116:119], v[208:211], v[92:95], v[116:119]
    v_exp_f32 v215, v139
    v_mfma_f32_16x16x32_bf16 v[124:127], v[208:211], v[108:111], v[124:127]
    s_waitcnt lgkmcnt(8)
    ds_read_b64_tr_b16 v[200:201], v7 offset:24576
    ds_read_b64_tr_b16 v[202:203], v7 offset:28672
    v_cvt_pk_bf16_f32 v157, v214, v215
    v_mfma_f32_16x16x32_bf16 v[48:51], v[176:179], v[144:147], v[48:51]
    v_exp_f32 v212, v140
    v_mfma_f32_16x16x32_bf16 v[52:55], v[176:179], v[148:151], v[52:55]
    s_waitcnt lgkmcnt(8)
    ds_read_b64_tr_b16 v[204:205], v6 offset:24832
    ds_read_b64_tr_b16 v[206:207], v6 offset:28928
    v_mfma_f32_16x16x32_bf16 v[56:59], v[180:183], v[144:147], v[56:59]
    v_exp_f32 v213, v141
    v_mfma_f32_16x16x32_bf16 v[60:63], v[180:183], v[148:151], v[60:63]
    s_waitcnt lgkmcnt(8)
    ds_read_b64_tr_b16 v[208:209], v7 offset:24832
    ds_read_b64_tr_b16 v[210:211], v7 offset:28928
    v_cvt_pk_bf16_f32 v158, v212, v213
    v_mfma_f32_16x16x32_bf16 v[64:67], v[184:187], v[144:147], v[64:67]
    v_exp_f32 v214, v142
    v_mfma_f32_16x16x32_bf16 v[68:71], v[184:187], v[148:151], v[68:71]
    s_waitcnt lgkmcnt(8)
    ds_read_b128 v[176:179], v5 offset:8704
    v_or3_b32 v15, v15, v157, v158
    v_mfma_f32_16x16x32_bf16 v[72:75], v[188:191], v[144:147], v[72:75]
    v_exp_f32 v215, v143
    v_mfma_f32_16x16x32_bf16 v[76:79], v[188:191], v[148:151], v[76:79]
    ds_read_b128 v[180:183], v5 offset:8768
    v_cvt_pk_bf16_f32 v159, v214, v215
    s_add_u32 m0, s68, 34816
    s_add_u32 s72, s80, 65536
    buffer_load_dwordx4 v237, s[40:43], s72 offen lds
    v_mfma_f32_16x16x32_bf16 v[216:219], v[172:175], v[144:147], v[216:219]
    v_or_b32 v15, v15, v159
    v_mfma_f32_16x16x32_bf16 v[220:223], v[172:175], v[148:151], v[220:223]
    s_waitcnt lgkmcnt(8)
    ds_read_b128 v[184:187], v5 offset:8832
    v_and_b32 v15, 0x40004000, v15
    v_cmp_ne_u32 vcc, 0, v15
    s_cbranch_vccnz L_rare_11
L_back_11:
    v_mfma_f32_16x16x32_bf16 v[16:19], v[196:199], v[152:155], v[16:19]
    v_exp_f32 v212, v112
    v_mfma_f32_16x16x32_bf16 v[20:23], v[196:199], v[156:159], v[20:23]
    s_waitcnt lgkmcnt(7)
    ds_read_b128 v[188:191], v5 offset:8896
    v_mfma_f32_16x16x32_bf16 v[24:27], v[200:203], v[152:155], v[24:27]
    v_exp_f32 v213, v113
    v_mfma_f32_16x16x32_bf16 v[28:31], v[200:203], v[156:159], v[28:31]
    s_waitcnt lgkmcnt(6)
    ds_read_b128 v[192:195], v5 offset:13056
    v_cvt_pk_bf16_f32 v144, v212, v213
    v_mfma_f32_16x16x32_bf16 v[32:35], v[204:207], v[152:155], v[32:35]
    v_exp_f32 v214, v114
    v_mfma_f32_16x16x32_bf16 v[36:39], v[204:207], v[156:159], v[36:39]
    s_waitcnt lgkmcnt(5)
    ds_read_b128 v[196:199], v5 offset:13120
    v_mfma_f32_16x16x32_bf16 v[40:43], v[208:211], v[152:155], v[40:43]
    v_exp_f32 v215, v115
    v_mfma_f32_16x16x32_bf16 v[44:47], v[208:211], v[156:159], v[44:47]
    s_waitcnt lgkmcnt(5)
    ds_read_b128 v[200:203], v5 offset:13184
    v_cvt_pk_bf16_f32 v145, v214, v215
    s_add_u32 m0, s68, 35840
    s_add_u32 s72, s80, 65536
    buffer_load_dwordx4 v238, s[40:43], s72 offen lds
    v_mfma_f32_16x16x32_bf16 v[128:131], v[176:179], v[80:83], v[160:163]
    v_exp_f32 v212, v116
    v_mfma_f32_16x16x32_bf16 v[136:139], v[176:179], v[96:99], v[164:167]
    s_waitcnt lgkmcnt(5)
    ds_read_b128 v[204:207], v5 offset:13248
    v_mfma_f32_16x16x32_bf16 v[128:131], v[180:183], v[84:87], v[128:131]
    v_exp_f32 v213, v117
    v_mfma_f32_16x16x32_bf16 v[136:139], v[180:183], v[100:103], v[136:139]
    s_waitcnt lgkmcnt(5)
    ds_read_b64_tr_b16 v[208:209], v6 offset:25088
    ds_read_b64_tr_b16 v[210:211], v6 offset:29184
    v_cvt_pk_bf16_f32 v146, v212, v213
    v_mfma_f32_16x16x32_bf16 v[128:131], v[184:187], v[88:91], v[128:131]
    v_exp_f32 v214, v118
    v_mfma_f32_16x16x32_bf16 v[136:139], v[184:187], v[104:107], v[136:139]
    s_waitcnt lgkmcnt(6)
    ds_read_b64_tr_b16 v[176:177], v7 offset:25088
    ds_read_b64_tr_b16 v[178:179], v7 offset:29184
    v_or3_b32 v15, v144, v145, v146
    v_mfma_f32_16x16x32_bf16 v[128:131], v[188:191], v[92:95], v[128:131]
    v_exp_f32 v215, v119
    v_mfma_f32_16x16x32_bf16 v[136:139], v[188:191], v[108:111], v[136:139]
    s_waitcnt lgkmcnt(7)
    ds_read_b64_tr_b16 v[180:181], v6 offset:25344
    ds_read_b64_tr_b16 v[182:183], v6 offset:29440
    v_cvt_pk_bf16_f32 v147, v214, v215
    v_mfma_f32_16x16x32_bf16 v[132:135], v[192:195], v[80:83], v[160:163]
    v_exp_f32 v212, v120
    v_mfma_f32_16x16x32_bf16 v[140:143], v[192:195], v[96:99], v[164:167]
    s_waitcnt lgkmcnt(8)
    ds_read_b64_tr_b16 v[184:185], v7 offset:25344
    ds_read_b64_tr_b16 v[186:187], v7 offset:29440
    v_mfma_f32_16x16x32_bf16 v[132:135], v[196:199], v[84:87], v[132:135]
    v_exp_f32 v213, v121
    v_mfma_f32_16x16x32_bf16 v[140:143], v[196:199], v[100:103], v[140:143]
    s_waitcnt lgkmcnt(9)
    v_cvt_pk_bf16_f32 v148, v212, v213
    v_mfma_f32_16x16x32_bf16 v[132:135], v[200:203], v[88:91], v[132:135]
    v_exp_f32 v214, v122
    v_mfma_f32_16x16x32_bf16 v[140:143], v[200:203], v[104:107], v[140:143]
    s_waitcnt lgkmcnt(8)
    v_or3_b32 v15, v15, v147, v148
    v_mfma_f32_16x16x32_bf16 v[132:135], v[204:207], v[92:95], v[132:135]
    v_exp_f32 v215, v123
    v_mfma_f32_16x16x32_bf16 v[140:143], v[204:207], v[108:111], v[140:143]
    s_waitcnt lgkmcnt(6)
    v_cvt_pk_bf16_f32 v149, v214, v215
    v_mfma_f32_16x16x32_bf16 v[48:51], v[208:211], v[152:155], v[48:51]
    v_exp_f32 v212, v124
    v_mfma_f32_16x16x32_bf16 v[52:55], v[208:211], v[156:159], v[52:55]
    s_waitcnt lgkmcnt(4)
    s_waitcnt vmcnt(4) lgkmcnt(0)
    s_barrier
    ds_read_b64_tr_b16 v[192:193], v6 offset:32768
    ds_read_b64_tr_b16 v[194:195], v6 offset:36864
    v_mfma_f32_16x16x32_bf16 v[56:59], v[176:179], v[152:155], v[56:59]
    ds_read_b64_tr_b16 v[196:197], v7 offset:32768
    v_exp_f32 v213, v125
    v_mfma_f32_16x16x32_bf16 v[60:63], v[176:179], v[156:159], v[60:63]
    ds_read_b64_tr_b16 v[198:199], v7 offset:36864
    ds_read_b64_tr_b16 v[200:201], v6 offset:33024
    v_cvt_pk_bf16_f32 v150, v212, v213
    s_add_u32 m0, s68, 69632
    s_add_u32 s72, s80, 98304
    buffer_load_dwordx4 v237, s[40:43], s72 offen lds
    v_mfma_f32_16x16x32_bf16 v[64:67], v[180:183], v[152:155], v[64:67]
    ds_read_b64_tr_b16 v[202:203], v6 offset:37120
    v_exp_f32 v214, v126
    v_mfma_f32_16x16x32_bf16 v[68:71], v[180:183], v[156:159], v[68:71]
    ds_read_b64_tr_b16 v[204:205], v7 offset:33024
    ds_read_b64_tr_b16 v[206:207], v7 offset:37120
    v_or3_b32 v15, v15, v149, v150
    v_mfma_f32_16x16x32_bf16 v[72:75], v[184:187], v[152:155], v[72:75]
    v_exp_f32 v215, v127
    v_mfma_f32_16x16x32_bf16 v[76:79], v[184:187], v[156:159], v[76:79]
    ds_read_b128 v[208:211], v5 offset:17408
    ds_read_b128 v[176:179], v5 offset:17472
    v_cvt_pk_bf16_f32 v151, v214, v215
    v_mfma_f32_16x16x32_bf16 v[216:219], v[172:175], v[152:155], v[216:219]
    v_or_b32 v15, v15, v151
    v_mfma_f32_16x16x32_bf16 v[220:223], v[172:175], v[156:159], v[220:223]
    s_waitcnt lgkmcnt(8)
    ds_read_b128 v[180:183], v5 offset:17536
    v_and_b32 v15, 0x40004000, v15
    v_cmp_ne_u32 vcc, 0, v15
    s_cbranch_vccnz L_rare_12
L_back_12:
    v_mfma_f32_16x16x32_bf16 v[16:19], v[192:195], v[144:147], v[16:19]
    v_exp_f32 v212, v128
    v_mfma_f32_16x16x32_bf16 v[20:23], v[192:195], v[148:151], v[20:23]
    s_waitcnt lgkmcnt(7)
    ds_read_b128 v[184:187], v5 offset:17600
    v_mfma_f32_16x16x32_bf16 v[24:27], v[196:199], v[144:147], v[24:27]
    v_exp_f32 v213, v129
    v_mfma_f32_16x16x32_bf16 v[28:31], v[196:199], v[148:151], v[28:31]
    s_waitcnt lgkmcnt(6)
    ds_read_b128 v[188:191], v5 offset:21760
    v_cvt_pk_bf16_f32 v152, v212, v213
    s_add_u32 m0, s68, 70656
    s_add_u32 s72, s80, 98304
    buffer_load_dwordx4 v238, s[40:43], s72 offen lds
    v_mfma_f32_16x16x32_bf16 v[32:35], v[200:203], v[144:147], v[32:35]
    v_exp_f32 v214, v130
    v_mfma_f32_16x16x32_bf16 v[36:39], v[200:203], v[148:151], v[36:39]
    s_waitcnt lgkmcnt(5)
    ds_read_b128 v[192:195], v5 offset:21824
    v_mfma_f32_16x16x32_bf16 v[40:43], v[204:207], v[144:147], v[40:43]
    v_exp_f32 v215, v131
    v_mfma_f32_16x16x32_bf16 v[44:47], v[204:207], v[148:151], v[44:47]
    s_waitcnt lgkmcnt(5)
    ds_read_b128 v[196:199], v5 offset:21888
    v_cvt_pk_bf16_f32 v153, v214, v215
    v_mfma_f32_16x16x32_bf16 v[112:115], v[208:211], v[80:83], v[160:163]
    v_exp_f32 v212, v132
    v_mfma_f32_16x16x32_bf16 v[120:123], v[208:211], v[96:99], v[164:167]
    s_waitcnt lgkmcnt(5)
    ds_read_b128 v[200:203], v5 offset:21952
    v_mfma_f32_16x16x32_bf16 v[112:115], v[176:179], v[84:87], v[112:115]
    v_exp_f32 v213, v133
    v_mfma_f32_16x16x32_bf16 v[120:123], v[176:179], v[100:103], v[120:123]
    s_waitcnt lgkmcnt(5)
    ds_read_b64_tr_b16 v[204:205], v6 offset:33280
    ds_read_b64_tr_b16 v[206:207], v6 offset:37376
    v_cvt_pk_bf16_f32 v154, v212, v213
    v_mfma_f32_16x16x32_bf16 v[112:115], v[180:183], v[88:91], v[112:115]
    v_exp_f32 v214, v134
    v_mfma_f32_16x16x32_bf16 v[120:123], v[180:183], v[104:107], v[120:123]
    s_waitcnt lgkmcnt(6)
    ds_read_b64_tr_b16 v[208:209], v7 offset:33280
    ds_read_b64_tr_b16 v[210:211], v7 offset:37376
    v_or3_b32 v15, v152, v153, v154
    s_add_u32 m0, s68, 0
    s_add_u32 s72, s81, 0
    buffer_load_dwordx4 v237, s[40:43], s72 offen lds
    v_mfma_f32_16x16x32_bf16 v[112:115], v[184:187], v[92:95], v[112:115]
    v_exp_f32 v215, v135
    v_mfma_f32_16x16x32_bf16 v[120:123], v[184:187], v[108:111], v[120:123]
    s_waitcnt lgkmcnt(7)
    ds_read_b64_tr_b16 v[176:177], v6 offset:33536
    ds_read_b64_tr_b16 v[178:179], v6 offset:37632
    v_cvt_pk_bf16_f32 v155, v214, v215
    v_mfma_f32_16x16x32_bf16 v[116:119], v[188:191], v[80:83], v[160:163]
    v_exp_f32 v212, v136
    v_mfma_f32_16x16x32_bf16 v[124:127], v[188:191], v[96:99], v[164:167]
    s_waitcnt lgkmcnt(8)
    ds_read_b64_tr_b16 v[180:181], v7 offset:33536
    ds_read_b64_tr_b16 v[182:183], v7 offset:37632
    v_mfma_f32_16x16x32_bf16 v[116:119], v[192:195], v[84:87], v[116:119]
    v_exp_f32 v213, v137
    v_mfma_f32_16x16x32_bf16 v[124:127], v[192:195], v[100:103], v[124:127]
    s_waitcnt lgkmcnt(9)
    v_cvt_pk_bf16_f32 v156, v212, v213
    v_mfma_f32_16x16x32_bf16 v[116:119], v[196:199], v[88:91], v[116:119]
    v_exp_f32 v214, v138
    v_mfma_f32_16x16x32_bf16 v[124:127], v[196:199], v[104:107], v[124:127]
    s_waitcnt lgkmcnt(8)
    ds_read_b64_tr_b16 v[188:189], v6 offset:40960
    ds_read_b64_tr_b16 v[190:191], v6 offset:45056
    v_or3_b32 v15, v15, v155, v156
    v_mfma_f32_16x16x32_bf16 v[116:119], v[200:203], v[92:95], v[116:119]
    v_exp_f32 v215, v139
    v_mfma_f32_16x16x32_bf16 v[124:127], v[200:203], v[108:111], v[124:127]
    s_waitcnt lgkmcnt(8)
    ds_read_b64_tr_b16 v[192:193], v7 offset:40960
    ds_read_b64_tr_b16 v[194:195], v7 offset:45056
    v_cvt_pk_bf16_f32 v157, v214, v215
    s_add_u32 m0, s68, 1024
    s_add_u32 s72, s81, 0
    buffer_load_dwordx4 v238, s[40:43], s72 offen lds
    v_mfma_f32_16x16x32_bf16 v[48:51], v[204:207], v[144:147], v[48:51]
    v_exp_f32 v212, v140
    v_mfma_f32_16x16x32_bf16 v[52:55], v[204:207], v[148:151], v[52:55]
    s_waitcnt lgkmcnt(8)
    ds_read_b64_tr_b16 v[196:197], v6 offset:41216
    ds_read_b64_tr_b16 v[198:199], v6 offset:45312
    v_mfma_f32_16x16x32_bf16 v[56:59], v[208:211], v[144:147], v[56:59]
    v_exp_f32 v213, v141
    v_mfma_f32_16x16x32_bf16 v[60:63], v[208:211], v[148:151], v[60:63]
    s_waitcnt lgkmcnt(8)
    ds_read_b64_tr_b16 v[200:201], v7 offset:41216
    ds_read_b64_tr_b16 v[202:203], v7 offset:45312
    v_cvt_pk_bf16_f32 v158, v212, v213
    v_mfma_f32_16x16x32_bf16 v[64:67], v[176:179], v[144:147], v[64:67]
    v_exp_f32 v214, v142
    v_mfma_f32_16x16x32_bf16 v[68:71], v[176:179], v[148:151], v[68:71]
    s_waitcnt lgkmcnt(8)
    ds_read_b128 v[204:207], v5 offset:26112
    v_or3_b32 v15, v15, v157, v158
    v_mfma_f32_16x16x32_bf16 v[72:75], v[180:183], v[144:147], v[72:75]
    v_exp_f32 v215, v143
    v_mfma_f32_16x16x32_bf16 v[76:79], v[180:183], v[148:151], v[76:79]
    ds_read_b128 v[208:211], v5 offset:26176
    v_cvt_pk_bf16_f32 v159, v214, v215
    v_mfma_f32_16x16x32_bf16 v[216:219], v[172:175], v[144:147], v[216:219]
    v_or_b32 v15, v15, v159
    v_mfma_f32_16x16x32_bf16 v[220:223], v[172:175], v[148:151], v[220:223]
    s_waitcnt lgkmcnt(8)
    ds_read_b128 v[176:179], v5 offset:26240
    v_and_b32 v15, 0x40004000, v15
    v_cmp_ne_u32 vcc, 0, v15
    s_cbranch_vccnz L_rare_13
L_back_13:
    s_add_u32 m0, s68, 86016
    s_add_u32 s72, s81, 32768
    buffer_load_dwordx4 v237, s[40:43], s72 offen lds
    v_mfma_f32_16x16x32_bf16 v[16:19], v[188:191], v[152:155], v[16:19]
    v_exp_f32 v212, v112
    v_mfma_f32_16x16x32_bf16 v[20:23], v[188:191], v[156:159], v[20:23]
    s_waitcnt lgkmcnt(7)
    ds_read_b128 v[180:183], v5 offset:26304
    v_mfma_f32_16x16x32_bf16 v[24:27], v[192:195], v[152:155], v[24:27]
    v_exp_f32 v213, v113
    v_mfma_f32_16x16x32_bf16 v[28:31], v[192:195], v[156:159], v[28:31]
    s_waitcnt lgkmcnt(6)
    ds_read_b128 v[184:187], v5 offset:30464
    v_cvt_pk_bf16_f32 v144, v212, v213
    v_mfma_f32_16x16x32_bf16 v[32:35], v[196:199], v[152:155], v[32:35]
    v_exp_f32 v214, v114
    v_mfma_f32_16x16x32_bf16 v[36:39], v[196:199], v[156:159], v[36:39]
    s_waitcnt lgkmcnt(5)
    ds_read_b128 v[188:191], v5 offset:30528
    v_mfma_f32_16x16x32_bf16 v[40:43], v[200:203], v[152:155], v[40:43]
    v_exp_f32 v215, v115
    v_mfma_f32_16x16x32_bf16 v[44:47], v[200:203], v[156:159], v[44:47]
    s_waitcnt lgkmcnt(5)
    ds_read_b128 v[192:195], v5 offset:30592
    v_cvt_pk_bf16_f32 v145, v214, v215
    v_mfma_f32_16x16x32_bf16 v[128:131], v[204:207], v[80:83], v[160:163]
    v_exp_f32 v212, v116
    v_mfma_f32_16x16x32_bf16 v[136:139], v[204:207], v[96:99], v[164:167]
    s_waitcnt lgkmcnt(5)
    ds_read_b128 v[196:199], v5 offset:30656
    s_add_u32 m0, s68, 87040
    s_add_u32 s72, s81, 32768
    buffer_load_dwordx4 v238, s[40:43], s72 offen lds
    v_mfma_f32_16x16x32_bf16 v[128:131], v[208:211], v[84:87], v[128:131]
    v_exp_f32 v213, v117
    v_mfma_f32_16x16x32_bf16 v[136:139], v[208:211], v[100:103], v[136:139]
    s_waitcnt lgkmcnt(5)
    ds_read_b64_tr_b16 v[200:201], v6 offset:41472
    ds_read_b64_tr_b16 v[202:203], v6 offset:45568
    v_cvt_pk_bf16_f32 v146, v212, v213
    v_mfma_f32_16x16x32_bf16 v[128:131], v[176:179], v[88:91], v[128:131]
    v_exp_f32 v214, v118
    v_mfma_f32_16x16x32_bf16 v[136:139], v[176:179], v[104:107], v[136:139]
    s_waitcnt lgkmcnt(6)
    ds_read_b64_tr_b16 v[204:205], v7 offset:41472
    ds_read_b64_tr_b16 v[206:207], v7 offset:45568
    v_or3_b32 v15, v144, v145, v146
    v_mfma_f32_16x16x32_bf16 v[128:131], v[180:183], v[92:95], v[128:131]
    v_exp_f32 v215, v119
    v_mfma_f32_16x16x32_bf16 v[136:139], v[180:183], v[108:111], v[136:139]
    s_waitcnt lgkmcnt(7)
    ds_read_b64_tr_b16 v[208:209], v6 offset:41728
    ds_read_b64_tr_b16 v[210:211], v6 offset:45824
    v_cvt_pk_bf16_f32 v147, v214, v215
    v_mfma_f32_16x16x32_bf16 v[132:135], v[184:187], v[80:83], v[160:163]
    v_exp_f32 v212, v120
    v_mfma_f32_16x16x32_bf16 v[140:143], v[184:187], v[96:99], v[164:167]
    s_waitcnt lgkmcnt(8)
    ds_read_b64_tr_b16 v[176:177], v7 offset:41728
    ds_read_b64_tr_b16 v[178:179], v7 offset:45824
    v_mfma_f32_16x16x32_bf16 v[132:135], v[188:191], v[84:87], v[132:135]
    v_exp_f32 v213, v121
    v_mfma_f32_16x16x32_bf16 v[140:143], v[188:191], v[100:103], v[140:143]
    s_waitcnt lgkmcnt(9)
    v_cvt_pk_bf16_f32 v148, v212, v213
    buffer_load_dword v248, v250, s[48:51], 0 offen sc1
    v_mfma_f32_16x16x32_bf16 v[132:135], v[192:195], v[88:91], v[132:135]
    v_exp_f32 v214, v122
    v_mfma_f32_16x16x32_bf16 v[140:143], v[192:195], v[104:107], v[140:143]
    s_waitcnt lgkmcnt(8)
    ds_read_b64_tr_b16 v[184:185], v6 offset:49152
    ds_read_b64_tr_b16 v[186:187], v6 offset:53248
    v_or3_b32 v15, v15, v147, v148
    v_mfma_f32_16x16x32_bf16 v[132:135], v[196:199], v[92:95], v[132:135]
    v_exp_f32 v215, v123
    v_mfma_f32_16x16x32_bf16 v[140:143], v[196:199], v[108:111], v[140:143]
    s_waitcnt lgkmcnt(8)
    ds_read_b64_tr_b16 v[188:189], v7 offset:49152
    ds_read_b64_tr_b16 v[190:191], v7 offset:53248
    v_cvt_pk_bf16_f32 v149, v214, v215
    v_mfma_f32_16x16x32_bf16 v[48:51], v[200:203], v[152:155], v[48:51]
    v_exp_f32 v212, v124
    v_mfma_f32_16x16x32_bf16 v[52:55], v[200:203], v[156:159], v[52:55]
    s_waitcnt lgkmcnt(8)
    ds_read_b64_tr_b16 v[192:193], v6 offset:49408
    ds_read_b64_tr_b16 v[194:195], v6 offset:53504
    v_mfma_f32_16x16x32_bf16 v[56:59], v[204:207], v[152:155], v[56:59]
    v_exp_f32 v213, v125
    v_mfma_f32_16x16x32_bf16 v[60:63], v[204:207], v[156:159], v[60:63]
    s_waitcnt lgkmcnt(8)
    ds_read_b64_tr_b16 v[196:197], v7 offset:49408
    ds_read_b64_tr_b16 v[198:199], v7 offset:53504
    v_cvt_pk_bf16_f32 v150, v212, v213
    v_mfma_f32_16x16x32_bf16 v[64:67], v[208:211], v[152:155], v[64:67]
    v_exp_f32 v214, v126
    v_mfma_f32_16x16x32_bf16 v[68:71], v[208:211], v[156:159], v[68:71]
    s_waitcnt lgkmcnt(8)
    ds_read_b64_tr_b16 v[200:201], v6 offset:49664
    ds_read_b64_tr_b16 v[202:203], v6 offset:53760
    v_or3_b32 v15, v15, v149, v150
    v_mfma_f32_16x16x32_bf16 v[72:75], v[176:179], v[152:155], v[72:75]
    v_exp_f32 v215, v127
    v_mfma_f32_16x16x32_bf16 v[76:79], v[176:179], v[156:159], v[76:79]
    ds_read_b64_tr_b16 v[204:205], v7 offset:49664
    ds_read_b64_tr_b16 v[206:207], v7 offset:53760
    v_cvt_pk_bf16_f32 v151, v214, v215
    v_mfma_f32_16x16x32_bf16 v[216:219], v[172:175], v[152:155], v[216:219]
    v_or_b32 v15, v15, v151
    v_mfma_f32_16x16x32_bf16 v[220:223], v[172:175], v[156:159], v[220:223]
    s_waitcnt lgkmcnt(10)
    ds_read_b64_tr_b16 v[208:209], v6 offset:49920
    ds_read_b64_tr_b16 v[210:211], v6 offset:54016
    v_and_b32 v15, 0x40004000, v15
    v_cmp_ne_u32 vcc, 0, v15
    s_cbranch_vccnz L_rare_14
L_back_14:
    v_mfma_f32_16x16x32_bf16 v[16:19], v[184:187], v[144:147], v[16:19]
    v_exp_f32 v212, v128
    v_mfma_f32_16x16x32_bf16 v[20:23], v[184:187], v[148:151], v[20:23]
    s_waitcnt lgkmcnt(10)
    ds_read_b64_tr_b16 v[176:177], v7 offset:49920
    ds_read_b64_tr_b16 v[178:179], v7 offset:54016
    v_exp_f32 v213, v129
    v_mfma_f32_16x16x32_bf16 v[24:27], v[188:191], v[144:147], v[24:27]
    v_exp_f32 v214, v130
    v_exp_f32 v215, v131
    v_mfma_f32_16x16x32_bf16 v[28:31], v[188:191], v[148:151], v[28:31]
    s_waitcnt lgkmcnt(10)
    v_cvt_pk_bf16_f32 v152, v212, v213
    v_mfma_f32_16x16x32_bf16 v[32:35], v[192:195], v[144:147], v[32:35]
    v_exp_f32 v212, v132
    v_exp_f32 v213, v133
    v_mfma_f32_16x16x32_bf16 v[36:39], v[192:195], v[148:151], v[36:39]
    s_waitcnt lgkmcnt(8)
    v_cvt_pk_bf16_f32 v153, v214, v215
    v_mfma_f32_16x16x32_bf16 v[40:43], v[196:199], v[144:147], v[40:43]
    v_exp_f32 v214, v134
    v_exp_f32 v215, v135
    v_mfma_f32_16x16x32_bf16 v[44:47], v[196:199], v[148:151], v[44:47]
    s_waitcnt lgkmcnt(6)
    ds_read_b64_tr_b16 v[188:189], v6 offset:57344
    ds_read_b64_tr_b16 v[190:191], v6 offset:61440
    v_cvt_pk_bf16_f32 v154, v212, v213
    v_mfma_f32_16x16x32_bf16 v[48:51], v[200:203], v[144:147], v[48:51]
    v_exp_f32 v212, v136
    v_mfma_f32_16x16x32_bf16 v[52:55], v[200:203], v[148:151], v[52:55]
    s_waitcnt lgkmcnt(6)
    ds_read_b64_tr_b16 v[192:193], v7 offset:57344
    ds_read_b64_tr_b16 v[194:195], v7 offset:61440
    v_exp_f32 v213, v137
    v_cvt_pk_bf16_f32 v155, v214, v215
    v_mfma_f32_16x16x32_bf16 v[56:59], v[204:207], v[144:147], v[56:59]
    v_exp_f32 v214, v138
    v_mfma_f32_16x16x32_bf16 v[60:63], v[204:207], v[148:151], v[60:63]
    s_waitcnt lgkmcnt(6)
    ds_read_b64_tr_b16 v[196:197], v6 offset:57600
    ds_read_b64_tr_b16 v[198:199], v6 offset:61696
    v_exp_f32 v215, v139
    v_cvt_pk_bf16_f32 v156, v212, v213
    v_mfma_f32_16x16x32_bf16 v[64:67], v[208:211], v[144:147], v[64:67]
    v_exp_f32 v212, v140
    v_mfma_f32_16x16x32_bf16 v[68:71], v[208:211], v[148:151], v[68:71]
    s_waitcnt lgkmcnt(6)
    ds_read_b64_tr_b16 v[200:201], v7 offset:57600
    ds_read_b64_tr_b16 v[202:203], v7 offset:61696
    v_exp_f32 v213, v141
    v_cvt_pk_bf16_f32 v157, v214, v215
    v_mfma_f32_16x16x32_bf16 v[72:75], v[176:179], v[144:147], v[72:75]
    v_exp_f32 v214, v142
    v_mfma_f32_16x16x32_bf16 v[76:79], v[176:179], v[148:151], v[76:79]
    ds_read_b64_tr_b16 v[204:205], v6 offset:57856
    ds_read_b64_tr_b16 v[206:207], v6 offset:61952
    v_exp_f32 v215, v143
    v_cvt_pk_bf16_f32 v158, v212, v213
    v_mfma_f32_16x16x32_bf16 v[216:219], v[172:175], v[144:147], v[216:219]
    v_cvt_pk_bf16_f32 v159, v214, v215
    v_or3_b32 v15, v152, v153, v154
    v_or3_b32 v15, v15, v155, v156
    v_mfma_f32_16x16x32_bf16 v[220:223], v[172:175], v[148:151], v[220:223]
    ds_read_b64_tr_b16 v[208:209], v7 offset:57856
    ds_read_b64_tr_b16 v[210:211], v7 offset:61952
    v_or3_b32 v15, v15, v157, v158
    v_or_b32 v15, v15, v159
    v_and_b32 v15, 0x40004000, v15
    v_cmp_ne_u32 vcc, 0, v15
    s_cbranch_vccnz L_rare_15
L_back_15:
    v_mfma_f32_16x16x32_bf16 v[216:219], v[172:175], v[152:155], v[216:219]
    v_mfma_f32_16x16x32_bf16 v[220:223], v[172:175], v[156:159], v[220:223]
    s_waitcnt lgkmcnt(10)
    ds_read_b64_tr_b16 v[176:177], v6 offset:58112
    ds_read_b64_tr_b16 v[178:179], v6 offset:62208
    v_mfma_f32_16x16x32_bf16 v[16:19], v[188:191], v[152:155], v[16:19]
    v_mfma_f32_16x16x32_bf16 v[20:23], v[188:191], v[156:159], v[20:23]
    s_waitcnt lgkmcnt(10)
    ds_read_b64_tr_b16 v[180:181], v7 offset:58112
    ds_read_b64_tr_b16 v[182:183], v7 offset:62208
    v_mfma_f32_16x16x32_bf16 v[24:27], v[192:195], v[152:155], v[24:27]
    v_mfma_f32_16x16x32_bf16 v[28:31], v[192:195], v[156:159], v[28:31]
    s_waitcnt lgkmcnt(10)
    v_rcp_f32 v8, v216
    v_mfma_f32_16x16x32_bf16 v[32:35], v[196:199], v[152:155], v[32:35]
    v_max_f32 v9, s88, v220
    v_mfma_f32_16x16x32_bf16 v[36:39], v[196:199], v[156:159], v[36:39]
    s_waitcnt lgkmcnt(8)
    v_rcp_f32 v9, v9
    v_mfma_f32_16x16x32_bf16 v[40:43], v[200:203], v[152:155], v[40:43]
    v_mfma_f32_16x16x32_bf16 v[44:47], v[200:203], v[156:159], v[44:47]
    s_waitcnt lgkmcnt(6)
    v_mul_f32 v16, v8, v16
    v_mul_f32 v17, v8, v17
    v_mul_f32 v18, v8, v18
    v_mul_f32 v19, v8, v19
    v_mul_f32 v20, v9, v20
    v_mfma_f32_16x16x32_bf16 v[48:51], v[204:207], v[152:155], v[48:51]
    v_mul_f32 v21, v9, v21
    v_mul_f32 v22, v9, v22
    v_mul_f32 v23, v9, v23
    v_mul_f32 v24, v8, v24
    v_mul_f32 v25, v8, v25
    v_mfma_f32_16x16x32_bf16 v[52:55], v[204:207], v[156:159], v[52:55]
    s_waitcnt lgkmcnt(4)
    v_mul_f32 v26, v8, v26
    v_mul_f32 v27, v8, v27
    v_mul_f32 v28, v9, v28
    v_mul_f32 v29, v9, v29
    v_mul_f32 v30, v9, v30
    v_mul_f32 v31, v9, v31
    v_mfma_f32_16x16x32_bf16 v[56:59], v[208:211], v[152:155], v[56:59]
    v_cvt_pk_bf16_f32 v16, v16, v17
    v_cvt_pk_bf16_f32 v17, v18, v19
    v_cvt_pk_bf16_f32 v18, v24, v25
    v_cvt_pk_bf16_f32 v19, v26, v27
    v_cvt_pk_bf16_f32 v20, v20, v21
    v_mfma_f32_16x16x32_bf16 v[60:63], v[208:211], v[156:159], v[60:63]
    s_waitcnt lgkmcnt(2)
    v_cvt_pk_bf16_f32 v21, v22, v23
    v_cvt_pk_bf16_f32 v22, v28, v29
    v_cvt_pk_bf16_f32 v23, v30, v31
    buffer_store_dwordx4 v[16:19], v236, s[36:39], 0 offen offset:0 sc1
    buffer_store_dwordx4 v[20:23], v236, s[36:39], s89 offen offset:0 sc1
    v_mfma_f32_16x16x32_bf16 v[64:67], v[176:179], v[152:155], v[64:67]
    v_mul_f32 v32, v8, v32
    v_mul_f32 v33, v8, v33
    v_mul_f32 v34, v8, v34
    v_mul_f32 v35, v8, v35
    v_mul_f32 v36, v9, v36
    v_mul_f32 v37, v9, v37
    v_mfma_f32_16x16x32_bf16 v[68:71], v[176:179], v[156:159], v[68:71]
    s_waitcnt lgkmcnt(0)
    v_mul_f32 v38, v9, v38
    v_mul_f32 v39, v9, v39
    v_mul_f32 v40, v8, v40
    v_mul_f32 v41, v8, v41
    v_mul_f32 v42, v8, v42
    v_mul_f32 v43, v8, v43
    v_mul_f32 v44, v9, v44
    v_mfma_f32_16x16x32_bf16 v[72:75], v[180:183], v[152:155], v[72:75]
    v_mul_f32 v45, v9, v45
    v_mul_f32 v46, v9, v46
    v_mul_f32 v47, v9, v47
    v_cvt_pk_bf16_f32 v32, v32, v33
    v_cvt_pk_bf16_f32 v33, v34, v35
    v_cvt_pk_bf16_f32 v34, v40, v41
    v_mfma_f32_16x16x32_bf16 v[76:79], v[180:183], v[156:159], v[76:79]
    v_cvt_pk_bf16_f32 v35, v42, v43
    v_cvt_pk_bf16_f32 v36, v36, v37
    v_cvt_pk_bf16_f32 v37, v38, v39
    v_cvt_pk_bf16_f32 v38, v44, v45
    v_cvt_pk_bf16_f32 v39, v46, v47
    buffer_store_dwordx4 v[32:35], v236, s[36:39], 0 offen offset:1024 sc1
    buffer_store_dwordx4 v[36:39], v236, s[36:39], s89 offen offset:1024 sc1
    v_mul_f32 v48, v8, v48
    v_mul_f32 v49, v8, v49
    v_mul_f32 v50, v8, v50
    v_mul_f32 v51, v8, v51
    v_mul_f32 v52, v9, v52
    v_mul_f32 v53, v9, v53
    v_mul_f32 v54, v9, v54
    v_mul_f32 v55, v9, v55
    v_mul_f32 v56, v8, v56
    v_mul_f32 v57, v8, v57
    v_mul_f32 v58, v8, v58
    v_mul_f32 v59, v8, v59
    v_mul_f32 v60, v9, v60
    v_mul_f32 v61, v9, v61
    v_mul_f32 v62, v9, v62
    v_mul_f32 v63, v9, v63
    v_cvt_pk_bf16_f32 v48, v48, v49
    v_cvt_pk_bf16_f32 v49, v50, v51
    v_cvt_pk_bf16_f32 v50, v56, v57
    v_cvt_pk_bf16_f32 v51, v58, v59
    v_cvt_pk_bf16_f32 v52, v52, v53
    v_cvt_pk_bf16_f32 v53, v54, v55
    v_cvt_pk_bf16_f32 v54, v60, v61
    v_cvt_pk_bf16_f32 v55, v62, v63
    buffer_store_dwordx4 v[48:51], v236, s[36:39], 0 offen offset:2048 sc1
    buffer_store_dwordx4 v[52:55], v236, s[36:39], s89 offen offset:2048 sc1
    v_mul_f32 v64, v8, v64
    v_mul_f32 v65, v8, v65
    v_mul_f32 v66, v8, v66
    v_mul_f32 v67, v8, v67
    v_mul_f32 v68, v9, v68
    v_mul_f32 v69, v9, v69
    v_mul_f32 v70, v9, v70
    v_mul_f32 v71, v9, v71
    v_mul_f32 v72, v8, v72
    v_mul_f32 v73, v8, v73
    v_mul_f32 v74, v8, v74
    v_mul_f32 v75, v8, v75
    v_mul_f32 v76, v9, v76
    v_mul_f32 v77, v9, v77
    v_mul_f32 v78, v9, v78
    v_mul_f32 v79, v9, v79
    v_cvt_pk_bf16_f32 v64, v64, v65
    v_cvt_pk_bf16_f32 v65, v66, v67
    v_cvt_pk_bf16_f32 v66, v72, v73
    v_cvt_pk_bf16_f32 v67, v74, v75
    v_cvt_pk_bf16_f32 v68, v68, v69
    v_cvt_pk_bf16_f32 v69, v70, v71
    v_cvt_pk_bf16_f32 v70, v76, v77
    v_cvt_pk_bf16_f32 v71, v78, v79
    buffer_store_dwordx4 v[64:67], v236, s[36:39], 0 offen offset:3072 sc1
    buffer_store_dwordx4 v[68:71], v236, s[36:39], s89 offen offset:3072 sc1
    v_add_u32 v5, 69632, v239
    v_add_u32 v6, 69632, v240
    v_add_u32 v7, 69632, v241
    v_add_u32 v10, 69632, v242
    s_and_b32 s63, s62, 4
    s_lshl_b32 s63, s63, 13
    s_lshl_b32 s64, s101, 11
    s_add_u32 s64, s64, s63
    v_add_u32 v12, s64, v236
    s_lshl_b32 s64, s101, 13
    s_add_u32 s64, s64, s63
    v_add_u32 v13, s64, v236
    s_mov_b32 s95, 100000
    s_waitcnt vmcnt(8)
    v_cmp_gt_u32 vcc, 32, v248
    s_mov_b64 s[76:77], vcc
    v_add_u32 v232, 135168, v239
    v_add_u32 v233, 135168, v240
    v_add_u32 v234, 135168, v241
    v_add_u32 v235, 135168, v242
    ds_read_b64_tr_b16 v[80:81], v232 offset:0
    ds_read_b64_tr_b16 v[84:85], v233 offset:0
    ds_read_b64_tr_b16 v[88:89], v234 offset:0
    ds_read_b64_tr_b16 v[92:93], v235 offset:0
    ds_read_b64_tr_b16 v[82:83], v232 offset:8192
    ds_read_b64_tr_b16 v[86:87], v233 offset:8192
    ds_read_b64_tr_b16 v[90:91], v234 offset:8192
    ds_read_b64_tr_b16 v[94:95], v235 offset:8192
    s_waitcnt vmcnt(0)
    buffer_store_dword v247, v243, s[56:59], 0 offen sc1
    s_setprio 2
    s_waitcnt lgkmcnt(0)
    s_barrier
    ds_read_b64_tr_b16 v[96:97], v239 offset:52224
    ds_read_b64_tr_b16 v[100:101], v240 offset:52224
    ds_read_b64_tr_b16 v[104:105], v241 offset:52224
    ds_read_b64_tr_b16 v[108:109], v242 offset:52224
    s_add_u32 m0, s68, 135168
    s_add_u32 s72, s81, 65536
    buffer_load_dwordx4 v237, s[40:43], s72 offen lds
    ds_read_b64_tr_b16 v[98:99], v239 offset:60416
    ds_read_b64_tr_b16 v[102:103], v240 offset:60416
    ds_read_b64_tr_b16 v[106:107], v241 offset:60416
    ds_read_b64_tr_b16 v[110:111], v242 offset:60416
    s_add_u32 m0, s68, 136192
    s_add_u32 s72, s81, 65536
    buffer_load_dwordx4 v238, s[40:43], s72 offen lds
    ds_read_b64_tr_b16 v[112:113], v239 offset:34816
    ds_read_b64_tr_b16 v[116:117], v240 offset:34816
    ds_read_b64_tr_b16 v[120:121], v241 offset:34816
    ds_read_b64_tr_b16 v[124:125], v242 offset:34816
    s_add_u32 m0, s68, 17408
    s_add_u32 s72, s81, 98304
    buffer_load_dwordx4 v237, s[40:43], s72 offen lds
    ds_read_b64_tr_b16 v[114:115], v239 offset:43008
    ds_read_b64_tr_b16 v[118:119], v240 offset:43008
    ds_read_b64_tr_b16 v[122:123], v241 offset:43008
    ds_read_b64_tr_b16 v[126:127], v242 offset:43008
    s_add_u32 m0, s68, 18432
    s_add_u32 s72, s81, 98304
    buffer_load_dwordx4 v238, s[40:43], s72 offen lds
    ds_read_b64_tr_b16 v[128:129], v5 offset:0
    ds_read_b64_tr_b16 v[132:133], v6 offset:0
    ds_read_b64_tr_b16 v[136:137], v7 offset:0
    ds_read_b64_tr_b16 v[140:141], v10 offset:0
    s_add_u32 m0, s68, 102400
    s_add_u32 s72, s82, 0
    buffer_load_dwordx4 v237, s[40:43], s72 offen lds
    ds_read_b64_tr_b16 v[130:131], v5 offset:8192
    ds_read_b64_tr_b16 v[134:135], v6 offset:8192
    ds_read_b64_tr_b16 v[138:139], v7 offset:8192
    ds_read_b64_tr_b16 v[142:143], v10 offset:8192
    s_add_u32 m0, s68, 103424
    s_add_u32 s72, s82, 0
    buffer_load_dwordx4 v238, s[40:43], s72 offen lds
    ds_read_b64_tr_b16 v[144:145], v239 offset:0
    ds_read_b64_tr_b16 v[148:149], v240 offset:0
    ds_read_b64_tr_b16 v[152:153], v241 offset:0
    ds_read_b64_tr_b16 v[156:157], v242 offset:0
    s_add_u32 m0, s68, 118784
    s_add_u32 s72, s82, 32768
    buffer_load_dwordx4 v237, s[40:43], s72 offen lds
    ds_read_b64_tr_b16 v[146:147], v239 offset:8192
    ds_read_b64_tr_b16 v[150:151], v240 offset:8192
    ds_read_b64_tr_b16 v[154:155], v241 offset:8192
    ds_read_b64_tr_b16 v[158:159], v242 offset:8192
    s_add_u32 m0, s68, 119808
    s_add_u32 s72, s82, 32768
    buffer_load_dwordx4 v238, s[40:43], s72 offen lds
    ds_read_b64_tr_b16 v[160:161], v5 offset:16384
    ds_read_b64_tr_b16 v[164:165], v6 offset:16384
    ds_read_b64_tr_b16 v[168:169], v7 offset:16384
    ds_read_b64_tr_b16 v[172:173], v10 offset:16384
    ds_read_b64_tr_b16 v[162:163], v5 offset:24576
    ds_read_b64_tr_b16 v[166:167], v6 offset:24576
    ds_read_b64_tr_b16 v[170:171], v7 offset:24576
    ds_read_b64_tr_b16 v[174:175], v10 offset:24576
    s_waitcnt lgkmcnt(0)
    s_barrier
    buffer_load_dword v248, v244, s[56:59], 0 offen sc1
    s_add_u32 m0, s68, 52224
    s_add_u32 s72, s82, 65536
    buffer_load_dwordx4 v237, s[40:43], s72 offen lds
    s_add_u32 m0, s68, 53248
    s_add_u32 s72, s82, 65536
    buffer_load_dwordx4 v238, s[40:43], s72 offen lds
    s_add_u32 m0, s68, 34816
    s_add_u32 s72, s82, 98304
    buffer_load_dwordx4 v237, s[40:43], s72 offen lds
    s_add_u32 m0, s68, 35840
    s_add_u32 s72, s82, 98304
    buffer_load_dwordx4 v238, s[40:43], s72 offen lds
    s_add_u32 m0, s68, 69632
    s_add_u32 s72, s83, 0
    buffer_load_dwordx4 v237, s[40:43], s72 offen lds
    s_add_u32 m0, s68, 70656
    s_add_u32 s72, s83, 0
    buffer_load_dwordx4 v238, s[40:43], s72 offen lds
    s_add_u32 m0, s68, 0
    s_add_u32 s72, s83, 32768
    buffer_load_dwordx4 v237, s[40:43], s72 offen lds
    s_add_u32 m0, s68, 1024
    s_add_u32 s72, s83, 32768
    buffer_load_dwordx4 v238, s[40:43], s72 offen lds
    s_add_u32 m0, s68, 86016
    s_add_u32 s72, s83, 65536
    buffer_load_dwordx4 v237, s[40:43], s72 offen lds
    s_add_u32 m0, s68, 87040
    s_add_u32 s72, s83, 65536
    buffer_load_dwordx4 v238, s[40:43], s72 offen lds
    s_cmp_eq_u64 s[76:77], 0
    s_cbranch_scc1 L_cnt_ok_o
L_cnt_o:
    s_sleep 2
    s_waitcnt vmcnt(0)
    buffer_load_dword v248, v250, s[48:51], 0 offen sc1
    s_waitcnt vmcnt(0)
    v_cmp_gt_u32 vcc, 32, v248
    v_mov_b32 v248, 0
    s_cbranch_vccz L_cnt_ok_o
    s_sub_u32 s95, s95, 1
    s_cmp_gt_i32 s95, 0
    s_cbranch_scc1 L_cnt_o
L_cnt_ok_o:
    s_waitcnt vmcnt(10)
    v_cmp_eq_u32 vcc, 0, v248
    s_cbranch_vccz L_go_o
L_poll_o:
    buffer_load_dword v248, v244, s[56:59], 0 offen sc1
    s_waitcnt vmcnt(0)
    v_cmp_eq_u32 vcc, 0, v248
    s_cbranch_vccz L_go_o
    s_sleep 1
    s_sub_u32 s95, s95, 1
    s_cmp_gt_i32 s95, 0
    s_cbranch_scc1 L_poll_o
L_go_o:
    s_lshr_b32 s73, s80, 5
    s_add_u32 s73, s73, s84
    buffer_load_dwordx4 v[192:195], v236, s[52:55], s73 offen offset:0 sc1
    s_lshr_b32 s73, s80, 5
    s_add_u32 s73, s73, s84
    s_add_u32 s73, s73, 131072
    buffer_load_dwordx4 v[196:199], v236, s[52:55], s73 offen offset:0 sc1
    s_lshr_b32 s73, s80, 5
    s_add_u32 s73, s73, s85
    buffer_load_dwordx4 v[200:203], v236, s[52:55], s73 offen offset:0 sc1
    s_lshr_b32 s73, s80, 5
    s_add_u32 s73, s73, s85
    s_add_u32 s73, s73, 131072
    buffer_load_dwordx4 v[204:207], v236, s[52:55], s73 offen offset:0 sc1
    s_lshr_b32 s73, s80, 5
    s_add_u32 s73, s73, s84
    buffer_load_dwordx4 v[208:211], v236, s[52:55], s73 offen offset:1024 sc1
    s_lshr_b32 s73, s80, 5
    s_add_u32 s73, s73, s84
    s_add_u32 s73, s73, 131072
    buffer_load_dwordx4 v[212:215], v236, s[52:55], s73 offen offset:1024 sc1
    s_lshr_b32 s73, s80, 5
    s_add_u32 s73, s73, s85
    buffer_load_dwordx4 v[216:219], v236, s[52:55], s73 offen offset:1024 sc1
    s_lshr_b32 s73, s80, 5
    s_add_u32 s73, s73, s85
    s_add_u32 s73, s73, 131072
    buffer_load_dwordx4 v[220:223], v236, s[52:55], s73 offen offset:1024 sc1
    s_lshr_b32 s73, s80, 5
    s_add_u32 s73, s73, s84
    buffer_load_dwordx4 v[224:227], v236, s[52:55], s73 offen offset:2048 sc1
    s_lshr_b32 s73, s80, 5
    s_add_u32 s73, s73, s84
    s_add_u32 s73, s73, 131072
    buffer_load_dwordx4 v[228:231], v236, s[52:55], s73 offen offset:2048 sc1
    s_waitcnt vmcnt(9)
    v_mfma_f32_16x16x32_bf16 v[16:19], v[80:83], v[192:195], 0
    v_mfma_f32_16x16x32_bf16 v[20:23], v[84:87], v[192:195], 0
    v_mfma_f32_16x16x32_bf16 v[24:27], v[88:91], v[192:195], 0
    v_mfma_f32_16x16x32_bf16 v[28:31], v[92:95], v[192:195], 0
    s_waitcnt vmcnt(8)
    v_mfma_f32_16x16x32_bf16 v[32:35], v[80:83], v[196:199], 0
    s_lshr_b32 s73, s80, 5
    s_add_u32 s73, s73, s85
    buffer_load_dwordx4 v[192:195], v236, s[52:55], s73 offen offset:2048 sc1
    v_mfma_f32_16x16x32_bf16 v[36:39], v[84:87], v[196:199], 0
    v_mfma_f32_16x16x32_bf16 v[40:43], v[88:91], v[196:199], 0
    v_mfma_f32_16x16x32_bf16 v[44:47], v[92:95], v[196:199], 0
    s_waitcnt vmcnt(8)
    v_mfma_f32_16x16x32_bf16 v[48:51], v[80:83], v[200:203], 0
    s_lshr_b32 s73, s80, 5
    s_add_u32 s73, s73, s85
    s_add_u32 s73, s73, 131072
    buffer_load_dwordx4 v[196:199], v236, s[52:55], s73 offen offset:2048 sc1
    v_mfma_f32_16x16x32_bf16 v[52:55], v[84:87], v[200:203], 0
    v_mfma_f32_16x16x32_bf16 v[56:59], v[88:91], v[200:203], 0
    v_mfma_f32_16x16x32_bf16 v[60:63], v[92:95], v[200:203], 0
    s_waitcnt vmcnt(8)
    v_mfma_f32_16x16x32_bf16 v[64:67], v[80:83], v[204:207], 0
    s_lshr_b32 s73, s80, 5
    s_add_u32 s73, s73, s84
    buffer_load_dwordx4 v[200:203], v236, s[52:55], s73 offen offset:3072 sc1
    v_mfma_f32_16x16x32_bf16 v[68:71], v[84:87], v[204:207], 0
    v_mfma_f32_16x16x32_bf16 v[72:75], v[88:91], v[204:207], 0
    v_mfma_f32_16x16x32_bf16 v[76:79], v[92:95], v[204:207], 0
    s_waitcnt vmcnt(8)
    v_mfma_f32_16x16x32_bf16 v[16:19], v[96:99], v[208:211], v[16:19]
    s_lshr_b32 s73, s80, 5
    s_add_u32 s73, s73, s84
    s_add_u32 s73, s73, 131072
    buffer_load_dwordx4 v[204:207], v236, s[52:55], s73 offen offset:3072 sc1
    v_mfma_f32_16x16x32_bf16 v[20:23], v[100:103], v[208:211], v[20:23]
    v_mfma_f32_16x16x32_bf16 v[24:27], v[104:107], v[208:211], v[24:27]
    v_mfma_f32_16x16x32_bf16 v[28:31], v[108:111], v[208:211], v[28:31]
    s_waitcnt vmcnt(8)
    v_mfma_f32_16x16x32_bf16 v[32:35], v[96:99], v[212:215], v[32:35]
    s_lshr_b32 s73, s80, 5
    s_add_u32 s73, s73, s85
    buffer_load_dwordx4 v[208:211], v236, s[52:55], s73 offen offset:3072 sc1
    v_mfma_f32_16x16x32_bf16 v[36:39], v[100:103], v[212:215], v[36:39]
    v_mfma_f32_16x16x32_bf16 v[40:43], v[104:107], v[212:215], v[40:43]
    v_mfma_f32_16x16x32_bf16 v[44:47], v[108:111], v[212:215], v[44:47]
    s_waitcnt vmcnt(8)
    v_mfma_f32_16x16x32_bf16 v[48:51], v[96:99], v[216:219], v[48:51]
    s_lshr_b32 s73, s80, 5
    s_add_u32 s73, s73, s85
    s_add_u32 s73, s73, 131072
    buffer_load_dwordx4 v[212:215], v236, s[52:55], s73 offen offset:3072 sc1
    v_mfma_f32_16x16x32_bf16 v[52:55], v[100:103], v[216:219], v[52:55]
    v_mfma_f32_16x16x32_bf16 v[56:59], v[104:107], v[216:219], v[56:59]
    v_mfma_f32_16x16x32_bf16 v[60:63], v[108:111], v[216:219], v[60:63]
    s_waitcnt vmcnt(8)
    v_mfma_f32_16x16x32_bf16 v[64:67], v[96:99], v[220:223], v[64:67]
    s_lshr_b32 s73, s81, 5
    s_add_u32 s73, s73, s84
    buffer_load_dwordx4 v[216:219], v236, s[52:55], s73 offen offset:0 sc1
    v_mfma_f32_16x16x32_bf16 v[68:71], v[100:103], v[220:223], v[68:71]
    v_mfma_f32_16x16x32_bf16 v[72:75], v[104:107], v[220:223], v[72:75]
    v_mfma_f32_16x16x32_bf16 v[76:79], v[108:111], v[220:223], v[76:79]
    s_waitcnt vmcnt(8)
    v_mfma_f32_16x16x32_bf16 v[16:19], v[112:115], v[224:227], v[16:19]
    s_lshr_b32 s73, s81, 5
    s_add_u32 s73, s73, s84
    s_add_u32 s73, s73, 131072
    buffer_load_dwordx4 v[220:223], v236, s[52:55], s73 offen offset:0 sc1
    v_mfma_f32_16x16x32_bf16 v[20:23], v[116:119], v[224:227], v[20:23]
    v_mfma_f32_16x16x32_bf16 v[24:27], v[120:123], v[224:227], v[24:27]
    v_mfma_f32_16x16x32_bf16 v[28:31], v[124:127], v[224:227], v[28:31]
    s_waitcnt vmcnt(8)
    v_mfma_f32_16x16x32_bf16 v[32:35], v[112:115], v[228:231], v[32:35]
    s_lshr_b32 s73, s81, 5
    s_add_u32 s73, s73, s85
    buffer_load_dwordx4 v[224:227], v236, s[52:55], s73 offen offset:0 sc1
    v_mfma_f32_16x16x32_bf16 v[36:39], v[116:119], v[228:231], v[36:39]
    v_mfma_f32_16x16x32_bf16 v[40:43], v[120:123], v[228:231], v[40:43]
    v_mfma_f32_16x16x32_bf16 v[44:47], v[124:127], v[228:231], v[44:47]
    s_waitcnt vmcnt(8)
    v_mfma_f32_16x16x32_bf16 v[48:51], v[112:115], v[192:195], v[48:51]
    s_lshr_b32 s73, s81, 5
    s_add_u32 s73, s73, s85
    s_add_u32 s73, s73, 131072
    buffer_load_dwordx4 v[228:231], v236, s[52:55], s73 offen offset:0 sc1
    v_mfma_f32_16x16x32_bf16 v[52:55], v[116:119], v[192:195], v[52:55]
    v_mfma_f32_16x16x32_bf16 v[56:59], v[120:123], v[192:195], v[56:59]
    v_mfma_f32_16x16x32_bf16 v[60:63], v[124:127], v[192:195], v[60:63]
    s_waitcnt vmcnt(8)
    v_mfma_f32_16x16x32_bf16 v[64:67], v[112:115], v[196:199], v[64:67]
    s_lshr_b32 s73, s81, 5
    s_add_u32 s73, s73, s84
    buffer_load_dwordx4 v[192:195], v236, s[52:55], s73 offen offset:1024 sc1
    v_mfma_f32_16x16x32_bf16 v[68:71], v[116:119], v[196:199], v[68:71]
    v_mfma_f32_16x16x32_bf16 v[72:75], v[120:123], v[196:199], v[72:75]
    v_mfma_f32_16x16x32_bf16 v[76:79], v[124:127], v[196:199], v[76:79]
    s_waitcnt vmcnt(8)
    v_mfma_f32_16x16x32_bf16 v[16:19], v[128:131], v[200:203], v[16:19]
    s_lshr_b32 s73, s81, 5
    s_add_u32 s73, s73, s84
    s_add_u32 s73, s73, 131072
    buffer_load_dwordx4 v[196:199], v236, s[52:55], s73 offen offset:1024 sc1
    v_mfma_f32_16x16x32_bf16 v[20:23], v[132:135], v[200:203], v[20:23]
    v_mfma_f32_16x16x32_bf16 v[24:27], v[136:139], v[200:203], v[24:27]
    v_mfma_f32_16x16x32_bf16 v[28:31], v[140:143], v[200:203], v[28:31]
    s_waitcnt vmcnt(8)
    v_mfma_f32_16x16x32_bf16 v[32:35], v[128:131], v[204:207], v[32:35]
    s_lshr_b32 s73, s81, 5
    s_add_u32 s73, s73, s85
    buffer_load_dwordx4 v[200:203], v236, s[52:55], s73 offen offset:1024 sc1
    v_mfma_f32_16x16x32_bf16 v[36:39], v[132:135], v[204:207], v[36:39]
    v_mfma_f32_16x16x32_bf16 v[40:43], v[136:139], v[204:207], v[40:43]
    v_mfma_f32_16x16x32_bf16 v[44:47], v[140:143], v[204:207], v[44:47]
    s_waitcnt vmcnt(8)
    v_mfma_f32_16x16x32_bf16 v[48:51], v[128:131], v[208:211], v[48:51]
    s_lshr_b32 s73, s81, 5
    s_add_u32 s73, s73, s85
    s_add_u32 s73, s73, 131072
    buffer_load_dwordx4 v[204:207], v236, s[52:55], s73 offen offset:1024 sc1
    v_mfma_f32_16x16x32_bf16 v[52:55], v[132:135], v[208:211], v[52:55]
    v_mfma_f32_16x16x32_bf16 v[56:59], v[136:139], v[208:211], v[56:59]
    v_mfma_f32_16x16x32_bf16 v[60:63], v[140:143], v[208:211], v[60:63]
    s_waitcnt vmcnt(8)
    v_mfma_f32_16x16x32_bf16 v[64:67], v[128:131], v[212:215], v[64:67]
    s_lshr_b32 s73, s81, 5
    s_add_u32 s73, s73, s84
    buffer_load_dwordx4 v[208:211], v236, s[52:55], s73 offen offset:2048 sc1
    v_mfma_f32_16x16x32_bf16 v[68:71], v[132:135], v[212:215], v[68:71]
    v_mfma_f32_16x16x32_bf16 v[72:75], v[136:139], v[212:215], v[72:75]
    v_mfma_f32_16x16x32_bf16 v[76:79], v[140:143], v[212:215], v[76:79]
    s_waitcnt vmcnt(8)
    v_mfma_f32_16x16x32_bf16 v[16:19], v[144:147], v[216:219], v[16:19]
    s_barrier
    v_add_u32 v232, 135168, v239
    v_add_u32 v233, 135168, v240
    v_add_u32 v234, 135168, v241
    v_add_u32 v235, 135168, v242
    s_lshr_b32 s73, s81, 5
    s_add_u32 s73, s73, s84
    s_add_u32 s73, s73, 131072
    buffer_load_dwordx4 v[212:215], v236, s[52:55], s73 offen offset:2048 sc1
    v_mfma_f32_16x16x32_bf16 v[20:23], v[148:151], v[216:219], v[20:23]
    ds_read_b64_tr_b16 v[176:177], v232 offset:0
    ds_read_b64_tr_b16 v[180:181], v233 offset:0
    v_mfma_f32_16x16x32_bf16 v[24:27], v[152:155], v[216:219], v[24:27]
    ds_read_b64_tr_b16 v[184:185], v234 offset:0
    v_mfma_f32_16x16x32_bf16 v[28:31], v[156:159], v[216:219], v[28:31]
    s_waitcnt vmcnt(8)
    ds_read_b64_tr_b16 v[188:189], v235 offset:0
    v_mfma_f32_16x16x32_bf16 v[32:35], v[144:147], v[220:223], v[32:35]
    s_lshr_b32 s73, s81, 5
    s_add_u32 s73, s73, s85
    buffer_load_dwordx4 v[216:219], v236, s[52:55], s73 offen offset:2048 sc1
    v_mfma_f32_16x16x32_bf16 v[36:39], v[148:151], v[220:223], v[36:39]
    ds_read_b64_tr_b16 v[178:179], v232 offset:8192
    ds_read_b64_tr_b16 v[182:183], v233 offset:8192
    v_mfma_f32_16x16x32_bf16 v[40:43], v[152:155], v[220:223], v[40:43]
    ds_read_b64_tr_b16 v[186:187], v234 offset:8192
    v_mfma_f32_16x16x32_bf16 v[44:47], v[156:159], v[220:223], v[44:47]
    s_waitcnt vmcnt(8)
    ds_read_b64_tr_b16 v[190:191], v235 offset:8192
    v_mfma_f32_16x16x32_bf16 v[48:51], v[144:147], v[224:227], v[48:51]
    s_lshr_b32 s73, s81, 5
    s_add_u32 s73, s73, s85
    s_add_u32 s73, s73, 131072
    buffer_load_dwordx4 v[220:223], v236, s[52:55], s73 offen offset:2048 sc1
    v_mfma_f32_16x16x32_bf16 v[52:55], v[148:151], v[224:227], v[52:55]
    ds_read_b64_tr_b16 v[80:81], v239 offset:17408
    ds_read_b64_tr_b16 v[84:85], v240 offset:17408
    v_mfma_f32_16x16x32_bf16 v[56:59], v[152:155], v[224:227], v[56:59]
    ds_read_b64_tr_b16 v[88:89], v241 offset:17408
    v_mfma_f32_16x16x32_bf16 v[60:63], v[156:159], v[224:227], v[60:63]
    s_waitcnt vmcnt(8)
    ds_read_b64_tr_b16 v[92:93], v242 offset:17408
    v_mfma_f32_16x16x32_bf16 v[64:67], v[144:147], v[228:231], v[64:67]
    s_lshr_b32 s73, s81, 5
    s_add_u32 s73, s73, s84
    buffer_load_dwordx4 v[224:227], v236, s[52:55], s73 offen offset:3072 sc1
    v_mfma_f32_16x16x32_bf16 v[68:71], v[148:151], v[228:231], v[68:71]
    ds_read_b64_tr_b16 v[82:83], v239 offset:25600
    ds_read_b64_tr_b16 v[86:87], v240 offset:25600
    v_mfma_f32_16x16x32_bf16 v[72:75], v[152:155], v[228:231], v[72:75]
    ds_read_b64_tr_b16 v[90:91], v241 offset:25600
    v_mfma_f32_16x16x32_bf16 v[76:79], v[156:159], v[228:231], v[76:79]
    s_waitcnt vmcnt(8)
    ds_read_b64_tr_b16 v[94:95], v242 offset:25600
    v_mfma_f32_16x16x32_bf16 v[16:19], v[160:163], v[192:195], v[16:19]
    s_lshr_b32 s73, s81, 5
    s_add_u32 s73, s73, s84
    s_add_u32 s73, s73, 131072
    buffer_load_dwordx4 v[228:231], v236, s[52:55], s73 offen offset:3072 sc1
    v_mfma_f32_16x16x32_bf16 v[20:23], v[164:167], v[192:195], v[20:23]
    ds_read_b64_tr_b16 v[96:97], v5 offset:32768
    ds_read_b64_tr_b16 v[100:101], v6 offset:32768
    v_mfma_f32_16x16x32_bf16 v[24:27], v[168:171], v[192:195], v[24:27]
    ds_read_b64_tr_b16 v[104:105], v7 offset:32768
    v_mfma_f32_16x16x32_bf16 v[28:31], v[172:175], v[192:195], v[28:31]
    s_waitcnt vmcnt(8)
    ds_read_b64_tr_b16 v[108:109], v10 offset:32768
    v_mfma_f32_16x16x32_bf16 v[32:35], v[160:163], v[196:199], v[32:35]
    s_lshr_b32 s73, s81, 5
    s_add_u32 s73, s73, s85
    buffer_load_dwordx4 v[192:195], v236, s[52:55], s73 offen offset:3072 sc1
    v_mfma_f32_16x16x32_bf16 v[36:39], v[164:167], v[196:199], v[36:39]
    ds_read_b64_tr_b16 v[98:99], v5 offset:40960
    ds_read_b64_tr_b16 v[102:103], v6 offset:40960
    v_mfma_f32_16x16x32_bf16 v[40:43], v[168:171], v[196:199], v[40:43]
    ds_read_b64_tr_b16 v[106:107], v7 offset:40960
    v_mfma_f32_16x16x32_bf16 v[44:47], v[172:175], v[196:199], v[44:47]
    s_waitcnt vmcnt(8)
    ds_read_b64_tr_b16 v[110:111], v10 offset:40960
    v_mfma_f32_16x16x32_bf16 v[48:51], v[160:163], v[200:203], v[48:51]
    s_lshr_b32 s73, s81, 5
    s_add_u32 s73, s73, s85
    s_add_u32 s73, s73, 131072
    buffer_load_dwordx4 v[196:199], v236, s[52:55], s73 offen offset:3072 sc1
    v_mfma_f32_16x16x32_bf16 v[52:55], v[164:167], v[200:203], v[52:55]
    ds_read_b64_tr_b16 v[112:113], v5 offset:49152
    ds_read_b64_tr_b16 v[116:117], v6 offset:49152
    v_mfma_f32_16x16x32_bf16 v[56:59], v[168:171], v[200:203], v[56:59]
    ds_read_b64_tr_b16 v[120:121], v7 offset:49152
    v_mfma_f32_16x16x32_bf16 v[60:63], v[172:175], v[200:203], v[60:63]
    s_waitcnt vmcnt(8)
    ds_read_b64_tr_b16 v[124:125], v10 offset:49152
    v_mfma_f32_16x16x32_bf16 v[64:67], v[160:163], v[204:207], v[64:67]
    s_lshr_b32 s73, s82, 5
    s_add_u32 s73, s73, s84
    buffer_load_dwordx4 v[200:203], v236, s[52:55], s73 offen offset:0 sc1
    v_mfma_f32_16x16x32_bf16 v[68:71], v[164:167], v[204:207], v[68:71]
    ds_read_b64_tr_b16 v[114:115], v5 offset:57344
    ds_read_b64_tr_b16 v[118:119], v6 offset:57344
    v_mfma_f32_16x16x32_bf16 v[72:75], v[168:171], v[204:207], v[72:75]
    ds_read_b64_tr_b16 v[122:123], v7 offset:57344
    v_mfma_f32_16x16x32_bf16 v[76:79], v[172:175], v[204:207], v[76:79]
    s_waitcnt vmcnt(8) lgkmcnt(15)
    ds_read_b64_tr_b16 v[126:127], v10 offset:57344
    v_mfma_f32_16x16x32_bf16 v[16:19], v[176:179], v[208:211], v[16:19]
    s_lshr_b32 s73, s82, 5
    s_add_u32 s73, s73, s84
    s_add_u32 s73, s73, 131072
    buffer_load_dwordx4 v[204:207], v236, s[52:55], s73 offen offset:0 sc1
    v_mfma_f32_16x16x32_bf16 v[20:23], v[180:183], v[208:211], v[20:23]
    ds_read_b64_tr_b16 v[128:129], v239 offset:52224
    ds_read_b64_tr_b16 v[132:133], v240 offset:52224
    v_mfma_f32_16x16x32_bf16 v[24:27], v[184:187], v[208:211], v[24:27]
    ds_read_b64_tr_b16 v[136:137], v241 offset:52224
    v_mfma_f32_16x16x32_bf16 v[28:31], v[188:191], v[208:211], v[28:31]
    s_waitcnt vmcnt(8)
    ds_read_b64_tr_b16 v[140:141], v242 offset:52224
    s_setprio 1
    v_mfma_f32_16x16x32_bf16 v[32:35], v[176:179], v[212:215], v[32:35]
    s_lshr_b32 s73, s82, 5
    s_add_u32 s73, s73, s85
    buffer_load_dwordx4 v[208:211], v236, s[52:55], s73 offen offset:0 sc1
    v_mfma_f32_16x16x32_bf16 v[36:39], v[180:183], v[212:215], v[36:39]
    ds_read_b64_tr_b16 v[130:131], v239 offset:60416
    ds_read_b64_tr_b16 v[134:135], v240 offset:60416
    v_mfma_f32_16x16x32_bf16 v[40:43], v[184:187], v[212:215], v[40:43]
    ds_read_b64_tr_b16 v[138:139], v241 offset:60416
    v_mfma_f32_16x16x32_bf16 v[44:47], v[188:191], v[212:215], v[44:47]
    s_waitcnt vmcnt(8)
    ds_read_b64_tr_b16 v[142:143], v242 offset:60416
    v_mfma_f32_16x16x32_bf16 v[48:51], v[176:179], v[216:219], v[48:51]
    s_lshr_b32 s73, s82, 5
    s_add_u32 s73, s73, s85
    s_add_u32 s73, s73, 131072
    buffer_load_dwordx4 v[212:215], v236, s[52:55], s73 offen offset:0 sc1
    v_mfma_f32_16x16x32_bf16 v[52:55], v[180:183], v[216:219], v[52:55]
    ds_read_b64_tr_b16 v[144:145], v239 offset:34816
    ds_read_b64_tr_b16 v[148:149], v240 offset:34816
    v_mfma_f32_16x16x32_bf16 v[56:59], v[184:187], v[216:219], v[56:59]
    ds_read_b64_tr_b16 v[152:153], v241 offset:34816
    v_mfma_f32_16x16x32_bf16 v[60:63], v[188:191], v[216:219], v[60:63]
    s_waitcnt vmcnt(8)
    ds_read_b64_tr_b16 v[156:157], v242 offset:34816
    v_mfma_f32_16x16x32_bf16 v[64:67], v[176:179], v[220:223], v[64:67]
    s_lshr_b32 s73, s82, 5
    s_add_u32 s73, s73, s84
    buffer_load_dwordx4 v[216:219], v236, s[52:55], s73 offen offset:1024 sc1
    v_mfma_f32_16x16x32_bf16 v[68:71], v[180:183], v[220:223], v[68:71]
    ds_read_b64_tr_b16 v[146:147], v239 offset:43008
    ds_read_b64_tr_b16 v[150:151], v240 offset:43008
    v_mfma_f32_16x16x32_bf16 v[72:75], v[184:187], v[220:223], v[72:75]
    ds_read_b64_tr_b16 v[154:155], v241 offset:43008
    v_mfma_f32_16x16x32_bf16 v[76:79], v[188:191], v[220:223], v[76:79]
    s_waitcnt vmcnt(8)
    ds_read_b64_tr_b16 v[158:159], v242 offset:43008
    v_mfma_f32_16x16x32_bf16 v[16:19], v[80:83], v[224:227], v[16:19]
    s_waitcnt lgkmcnt(0)
    s_barrier
    s_lshr_b32 s73, s82, 5
    s_add_u32 s73, s73, s84
    s_add_u32 s73, s73, 131072
    buffer_load_dwordx4 v[220:223], v236, s[52:55], s73 offen offset:1024 sc1
    v_mfma_f32_16x16x32_bf16 v[20:23], v[84:87], v[224:227], v[20:23]
    ds_read_b64_tr_b16 v[160:161], v5 offset:0
    ds_read_b64_tr_b16 v[164:165], v6 offset:0
    v_mfma_f32_16x16x32_bf16 v[24:27], v[88:91], v[224:227], v[24:27]
    s_add_u32 m0, s68, 135168
    s_add_u32 s72, s83, 98304
    buffer_load_dwordx4 v237, s[40:43], s72 offen lds
    ds_read_b64_tr_b16 v[168:169], v7 offset:0
    v_mfma_f32_16x16x32_bf16 v[28:31], v[92:95], v[224:227], v[28:31]
    s_waitcnt vmcnt(9)
    ds_read_b64_tr_b16 v[172:173], v10 offset:0
    v_mfma_f32_16x16x32_bf16 v[32:35], v[80:83], v[228:231], v[32:35]
    s_lshr_b32 s73, s82, 5
    s_add_u32 s73, s73, s84
    buffer_load_dwordx4 v[224:227], v236, s[52:55], s73 offen offset:2048 sc1
    v_mfma_f32_16x16x32_bf16 v[36:39], v[84:87], v[228:231], v[36:39]
    ds_read_b64_tr_b16 v[162:163], v5 offset:8192
    ds_read_b64_tr_b16 v[166:167], v6 offset:8192
    v_mfma_f32_16x16x32_bf16 v[40:43], v[88:91], v[228:231], v[40:43]
    s_add_u32 m0, s68, 136192
    s_add_u32 s72, s83, 98304
    buffer_load_dwordx4 v238, s[40:43], s72 offen lds
    ds_read_b64_tr_b16 v[170:171], v7 offset:8192
    v_mfma_f32_16x16x32_bf16 v[44:47], v[92:95], v[228:231], v[44:47]
    s_waitcnt vmcnt(10)
    ds_read_b64_tr_b16 v[174:175], v10 offset:8192
    v_mfma_f32_16x16x32_bf16 v[48:51], v[80:83], v[192:195], v[48:51]
    s_lshr_b32 s73, s82, 5
    s_add_u32 s73, s73, s84
    s_add_u32 s73, s73, 131072
    buffer_load_dwordx4 v[228:231], v236, s[52:55], s73 offen offset:2048 sc1
    v_mfma_f32_16x16x32_bf16 v[52:55], v[84:87], v[192:195], v[52:55]
    ds_read_b64_tr_b16 v[176:177], v239 offset:0
    ds_read_b64_tr_b16 v[180:181], v240 offset:0
    v_mfma_f32_16x16x32_bf16 v[56:59], v[88:91], v[192:195], v[56:59]
    ds_read_b64_tr_b16 v[184:185], v241 offset:0
    v_mfma_f32_16x16x32_bf16 v[60:63], v[92:95], v[192:195], v[60:63]
    s_waitcnt vmcnt(10)
    ds_read_b64_tr_b16 v[188:189], v242 offset:0
    v_mfma_f32_16x16x32_bf16 v[64:67], v[80:83], v[196:199], v[64:67]
    s_lshr_b32 s73, s82, 5
    s_add_u32 s73, s73, s84
    buffer_load_dwordx4 v[192:195], v236, s[52:55], s73 offen offset:3072 sc1
    v_mfma_f32_16x16x32_bf16 v[68:71], v[84:87], v[196:199], v[68:71]
    ds_read_b64_tr_b16 v[178:179], v239 offset:8192
    ds_read_b64_tr_b16 v[182:183], v240 offset:8192
    v_mfma_f32_16x16x32_bf16 v[72:75], v[88:91], v[196:199], v[72:75]
    ds_read_b64_tr_b16 v[186:187], v241 offset:8192
    v_mfma_f32_16x16x32_bf16 v[76:79], v[92:95], v[196:199], v[76:79]
    s_waitcnt vmcnt(10)
    ds_read_b64_tr_b16 v[190:191], v242 offset:8192
    v_mfma_f32_16x16x32_bf16 v[16:19], v[96:99], v[200:203], v[16:19]
    s_lshr_b32 s73, s82, 5
    s_add_u32 s73, s73, s84
    s_add_u32 s73, s73, 131072
    buffer_load_dwordx4 v[196:199], v236, s[52:55], s73 offen offset:3072 sc1
    v_mfma_f32_16x16x32_bf16 v[20:23], v[100:103], v[200:203], v[20:23]
    ds_read_b64_tr_b16 v[80:81], v5 offset:16384
    ds_read_b64_tr_b16 v[84:85], v6 offset:16384
    v_mfma_f32_16x16x32_bf16 v[24:27], v[104:107], v[200:203], v[24:27]
    ds_read_b64_tr_b16 v[88:89], v7 offset:16384
    v_mfma_f32_16x16x32_bf16 v[28:31], v[108:111], v[200:203], v[28:31]
    s_waitcnt vmcnt(10)
    ds_read_b64_tr_b16 v[92:93], v10 offset:16384
    v_mfma_f32_16x16x32_bf16 v[32:35], v[96:99], v[204:207], v[32:35]
    s_lshr_b32 s73, s83, 5
    s_add_u32 s73, s73, s84
    buffer_load_dwordx4 v[200:203], v236, s[52:55], s73 offen offset:0 sc1
    v_mfma_f32_16x16x32_bf16 v[36:39], v[100:103], v[204:207], v[36:39]
    ds_read_b64_tr_b16 v[82:83], v5 offset:24576
    ds_read_b64_tr_b16 v[86:87], v6 offset:24576
    v_mfma_f32_16x16x32_bf16 v[40:43], v[104:107], v[204:207], v[40:43]
    ds_read_b64_tr_b16 v[90:91], v7 offset:24576
    v_mfma_f32_16x16x32_bf16 v[44:47], v[108:111], v[204:207], v[44:47]
    s_waitcnt vmcnt(10)
    ds_read_b64_tr_b16 v[94:95], v10 offset:24576
    v_mfma_f32_16x16x32_bf16 v[48:51], v[96:99], v[208:211], v[48:51]
    s_lshr_b32 s73, s83, 5
    s_add_u32 s73, s73, s84
    s_add_u32 s73, s73, 131072
    buffer_load_dwordx4 v[204:207], v236, s[52:55], s73 offen offset:0 sc1
    v_mfma_f32_16x16x32_bf16 v[52:55], v[100:103], v[208:211], v[52:55]
    v_mfma_f32_16x16x32_bf16 v[56:59], v[104:107], v[208:211], v[56:59]
    v_mfma_f32_16x16x32_bf16 v[60:63], v[108:111], v[208:211], v[60:63]
    s_waitcnt vmcnt(10)
    v_mfma_f32_16x16x32_bf16 v[64:67], v[96:99], v[212:215], v[64:67]
    s_lshr_b32 s73, s83, 5
    s_add_u32 s73, s73, s84
    buffer_load_dwordx4 v[208:211], v236, s[52:55], s73 offen offset:1024 sc1
    v_mfma_f32_16x16x32_bf16 v[68:71], v[100:103], v[212:215], v[68:71]
    v_mfma_f32_16x16x32_bf16 v[72:75], v[104:107], v[212:215], v[72:75]
    v_mfma_f32_16x16x32_bf16 v[76:79], v[108:111], v[212:215], v[76:79]
    s_waitcnt vmcnt(10)
    v_mfma_f32_16x16x32_bf16 v[16:19], v[112:115], v[216:219], v[16:19]
    s_lshr_b32 s73, s83, 5
    s_add_u32 s73, s73, s84
    s_add_u32 s73, s73, 131072
    buffer_load_dwordx4 v[212:215], v236, s[52:55], s73 offen offset:1024 sc1
    v_mfma_f32_16x16x32_bf16 v[20:23], v[116:119], v[216:219], v[20:23]
    v_mfma_f32_16x16x32_bf16 v[24:27], v[120:123], v[216:219], v[24:27]
    v_mfma_f32_16x16x32_bf16 v[28:31], v[124:127], v[216:219], v[28:31]
    s_waitcnt vmcnt(10)
    v_mfma_f32_16x16x32_bf16 v[32:35], v[112:115], v[220:223], v[32:35]
    s_lshr_b32 s73, s83, 5
    s_add_u32 s73, s73, s84
    buffer_load_dwordx4 v[216:219], v236, s[52:55], s73 offen offset:2048 sc1
    v_mfma_f32_16x16x32_bf16 v[36:39], v[116:119], v[220:223], v[36:39]
    v_mfma_f32_16x16x32_bf16 v[40:43], v[120:123], v[220:223], v[40:43]
    v_mfma_f32_16x16x32_bf16 v[44:47], v[124:127], v[220:223], v[44:47]
    s_waitcnt vmcnt(9)
    v_mfma_f32_16x16x32_bf16 v[16:19], v[128:131], v[224:227], v[16:19]
    s_lshr_b32 s73, s83, 5
    s_add_u32 s73, s73, s84
    s_add_u32 s73, s73, 131072
    buffer_load_dwordx4 v[220:223], v236, s[52:55], s73 offen offset:2048 sc1
    v_mfma_f32_16x16x32_bf16 v[20:23], v[132:135], v[224:227], v[20:23]
    v_mfma_f32_16x16x32_bf16 v[24:27], v[136:139], v[224:227], v[24:27]
    v_mfma_f32_16x16x32_bf16 v[28:31], v[140:143], v[224:227], v[28:31]
    s_waitcnt vmcnt(8)
    v_mfma_f32_16x16x32_bf16 v[32:35], v[128:131], v[228:231], v[32:35]
    s_lshr_b32 s73, s83, 5
    s_add_u32 s73, s73, s84
    buffer_load_dwordx4 v[224:227], v236, s[52:55], s73 offen offset:3072 sc1
    v_mfma_f32_16x16x32_bf16 v[36:39], v[132:135], v[228:231], v[36:39]
    v_mfma_f32_16x16x32_bf16 v[40:43], v[136:139], v[228:231], v[40:43]
    v_mfma_f32_16x16x32_bf16 v[44:47], v[140:143], v[228:231], v[44:47]
    s_waitcnt vmcnt(8)
    v_mfma_f32_16x16x32_bf16 v[16:19], v[144:147], v[192:195], v[16:19]
    s_waitcnt lgkmcnt(0)
    s_barrier
    v_add_u32 v232, 135168, v239
    v_add_u32 v233, 135168, v240
    v_add_u32 v234, 135168, v241
    v_add_u32 v235, 135168, v242
    s_lshr_b32 s73, s83, 5
    s_add_u32 s73, s73, s84
    s_add_u32 s73, s73, 131072
    buffer_load_dwordx4 v[228:231], v236, s[52:55], s73 offen offset:3072 sc1
    v_mfma_f32_16x16x32_bf16 v[20:23], v[148:151], v[192:195], v[20:23]
    ds_read_b64_tr_b16 v[96:97], v232 offset:0
    ds_read_b64_tr_b16 v[100:101], v233 offset:0
    v_mfma_f32_16x16x32_bf16 v[24:27], v[152:155], v[192:195], v[24:27]
    ds_read_b64_tr_b16 v[104:105], v234 offset:0
    v_mfma_f32_16x16x32_bf16 v[28:31], v[156:159], v[192:195], v[28:31]
    s_waitcnt vmcnt(8)
    ds_read_b64_tr_b16 v[108:109], v235 offset:0
    v_mfma_f32_16x16x32_bf16 v[32:35], v[144:147], v[196:199], v[32:35]
    s_lshr_b32 s73, s82, 5
    s_add_u32 s73, s73, s85
    buffer_load_dwordx4 v[192:195], v236, s[52:55], s73 offen offset:1024 sc1
    v_mfma_f32_16x16x32_bf16 v[36:39], v[148:151], v[196:199], v[36:39]
    ds_read_b64_tr_b16 v[98:99], v232 offset:8192
    ds_read_b64_tr_b16 v[102:103], v233 offset:8192
    v_mfma_f32_16x16x32_bf16 v[40:43], v[152:155], v[196:199], v[40:43]
    ds_read_b64_tr_b16 v[106:107], v234 offset:8192
    v_mfma_f32_16x16x32_bf16 v[44:47], v[156:159], v[196:199], v[44:47]
    s_waitcnt vmcnt(8)
    ds_read_b64_tr_b16 v[110:111], v235 offset:8192
    v_mfma_f32_16x16x32_bf16 v[16:19], v[160:163], v[200:203], v[16:19]
    s_lshr_b32 s73, s82, 5
    s_add_u32 s73, s73, s85
    s_add_u32 s73, s73, 131072
    buffer_load_dwordx4 v[196:199], v236, s[52:55], s73 offen offset:1024 sc1
    v_mfma_f32_16x16x32_bf16 v[20:23], v[164:167], v[200:203], v[20:23]
    v_mfma_f32_16x16x32_bf16 v[24:27], v[168:171], v[200:203], v[24:27]
    v_mfma_f32_16x16x32_bf16 v[28:31], v[172:175], v[200:203], v[28:31]
    s_waitcnt vmcnt(8)
    v_mfma_f32_16x16x32_bf16 v[32:35], v[160:163], v[204:207], v[32:35]
    s_lshr_b32 s73, s82, 5
    s_add_u32 s73, s73, s85
    buffer_load_dwordx4 v[200:203], v236, s[52:55], s73 offen offset:2048 sc1
    v_mfma_f32_16x16x32_bf16 v[36:39], v[164:167], v[204:207], v[36:39]
    v_mfma_f32_16x16x32_bf16 v[40:43], v[168:171], v[204:207], v[40:43]
    v_mfma_f32_16x16x32_bf16 v[44:47], v[172:175], v[204:207], v[44:47]
    s_waitcnt vmcnt(8)
    v_mfma_f32_16x16x32_bf16 v[16:19], v[176:179], v[208:211], v[16:19]
    s_lshr_b32 s73, s82, 5
    s_add_u32 s73, s73, s85
    s_add_u32 s73, s73, 131072
    buffer_load_dwordx4 v[204:207], v236, s[52:55], s73 offen offset:2048 sc1
    v_mfma_f32_16x16x32_bf16 v[20:23], v[180:183], v[208:211], v[20:23]
    v_mfma_f32_16x16x32_bf16 v[24:27], v[184:187], v[208:211], v[24:27]
    v_mfma_f32_16x16x32_bf16 v[28:31], v[188:191], v[208:211], v[28:31]
    s_waitcnt vmcnt(8)
    s_setprio 0
    v_mfma_f32_16x16x32_bf16 v[32:35], v[176:179], v[212:215], v[32:35]
    s_lshr_b32 s73, s82, 5
    s_add_u32 s73, s73, s85
    buffer_load_dwordx4 v[208:211], v236, s[52:55], s73 offen offset:3072 sc1
    v_mfma_f32_16x16x32_bf16 v[36:39], v[180:183], v[212:215], v[36:39]
    v_mfma_f32_16x16x32_bf16 v[40:43], v[184:187], v[212:215], v[40:43]
    v_mfma_f32_16x16x32_bf16 v[44:47], v[188:191], v[212:215], v[44:47]
    s_waitcnt vmcnt(8)
    v_mfma_f32_16x16x32_bf16 v[16:19], v[80:83], v[216:219], v[16:19]
    s_waitcnt lgkmcnt(0)
    s_barrier
    s_lshr_b32 s73, s82, 5
    s_add_u32 s73, s73, s85
    s_add_u32 s73, s73, 131072
    buffer_load_dwordx4 v[212:215], v236, s[52:55], s73 offen offset:3072 sc1
    v_mfma_f32_16x16x32_bf16 v[20:23], v[84:87], v[216:219], v[20:23]
    v_mfma_f32_16x16x32_bf16 v[24:27], v[88:91], v[216:219], v[24:27]
    v_mfma_f32_16x16x32_bf16 v[28:31], v[92:95], v[216:219], v[28:31]
    s_waitcnt vmcnt(8)
    v_mfma_f32_16x16x32_bf16 v[32:35], v[80:83], v[220:223], v[32:35]
    s_lshr_b32 s73, s83, 5
    s_add_u32 s73, s73, s85
    buffer_load_dwordx4 v[216:219], v236, s[52:55], s73 offen offset:0 sc1
    v_mfma_f32_16x16x32_bf16 v[36:39], v[84:87], v[220:223], v[36:39]
    v_mfma_f32_16x16x32_bf16 v[40:43], v[88:91], v[220:223], v[40:43]
    v_mfma_f32_16x16x32_bf16 v[44:47], v[92:95], v[220:223], v[44:47]
    s_waitcnt vmcnt(8)
    v_mfma_f32_16x16x32_bf16 v[16:19], v[96:99], v[224:227], v[16:19]
    s_lshr_b32 s73, s83, 5
    s_add_u32 s73, s73, s85
    s_add_u32 s73, s73, 131072
    buffer_load_dwordx4 v[220:223], v236, s[52:55], s73 offen offset:0 sc1
    v_mfma_f32_16x16x32_bf16 v[20:23], v[100:103], v[224:227], v[20:23]
    v_mfma_f32_16x16x32_bf16 v[24:27], v[104:107], v[224:227], v[24:27]
    v_mfma_f32_16x16x32_bf16 v[28:31], v[108:111], v[224:227], v[28:31]
    s_waitcnt vmcnt(8)
    v_mfma_f32_16x16x32_bf16 v[32:35], v[96:99], v[228:231], v[32:35]
    s_lshr_b32 s73, s83, 5
    s_add_u32 s73, s73, s85
    buffer_load_dwordx4 v[224:227], v236, s[52:55], s73 offen offset:1024 sc1
    v_mfma_f32_16x16x32_bf16 v[36:39], v[100:103], v[228:231], v[36:39]
    v_mfma_f32_16x16x32_bf16 v[40:43], v[104:107], v[228:231], v[40:43]
    v_mfma_f32_16x16x32_bf16 v[44:47], v[108:111], v[228:231], v[44:47]
    s_waitcnt vmcnt(8)
    v_mfma_f32_16x16x32_bf16 v[48:51], v[112:115], v[192:195], v[48:51]
    s_lshr_b32 s73, s83, 5
    s_add_u32 s73, s73, s85
    buffer_load_dwordx4 v[228:231], v236, s[52:55], s73 offen offset:2048 sc1
    v_mfma_f32_16x16x32_bf16 v[52:55], v[116:119], v[192:195], v[52:55]
    v_mfma_f32_16x16x32_bf16 v[56:59], v[120:123], v[192:195], v[56:59]
    v_mfma_f32_16x16x32_bf16 v[60:63], v[124:127], v[192:195], v[60:63]
    s_waitcnt vmcnt(8)
    v_mfma_f32_16x16x32_bf16 v[64:67], v[112:115], v[196:199], v[64:67]
    s_lshr_b32 s73, s83, 5
    s_add_u32 s73, s73, s85
    buffer_load_dwordx4 v[192:195], v236, s[52:55], s73 offen offset:3072 sc1
    ds_write_b128 v12, v[16:19] offset:0
    v_mfma_f32_16x16x32_bf16 v[68:71], v[116:119], v[196:199], v[68:71]
    ds_write_b128 v12, v[20:23] offset:1024
    v_mfma_f32_16x16x32_bf16 v[72:75], v[120:123], v[196:199], v[72:75]
    ds_write_b128 v12, v[24:27] offset:8192
    v_mfma_f32_16x16x32_bf16 v[76:79], v[124:127], v[196:199], v[76:79]
    s_waitcnt vmcnt(8)
    ds_write_b128 v12, v[28:31] offset:9216
    v_mfma_f32_16x16x32_bf16 v[48:51], v[128:131], v[200:203], v[48:51]
    s_lshr_b32 s73, s83, 5
    s_add_u32 s73, s73, s85
    s_add_u32 s73, s73, 131072
    buffer_load_dwordx4 v[196:199], v236, s[52:55], s73 offen offset:1024 sc1
    ds_write_b128 v12, v[32:35] offset:16384
    v_mfma_f32_16x16x32_bf16 v[52:55], v[132:135], v[200:203], v[52:55]
    ds_write_b128 v12, v[36:39] offset:17408
    v_mfma_f32_16x16x32_bf16 v[56:59], v[136:139], v[200:203], v[56:59]
    s_lshr_b32 s73, s83, 5
    s_add_u32 s73, s73, s85
    s_add_u32 s73, s73, 131072
    buffer_load_dwordx4 v[112:115], v236, s[52:55], s73 offen offset:2048 sc1
    ds_write_b128 v12, v[40:43] offset:24576
    v_mfma_f32_16x16x32_bf16 v[60:63], v[140:143], v[200:203], v[60:63]
    s_waitcnt vmcnt(9)
    ds_write_b128 v12, v[44:47] offset:25600
    v_mfma_f32_16x16x32_bf16 v[64:67], v[128:131], v[204:207], v[64:67]
    s_lshr_b32 s73, s83, 5
    s_add_u32 s73, s73, s85
    s_add_u32 s73, s73, 131072
    buffer_load_dwordx4 v[116:119], v236, s[52:55], s73 offen offset:3072 sc1
    s_waitcnt lgkmcnt(0)
    s_barrier
    v_mfma_f32_16x16x32_bf16 v[68:71], v[132:135], v[204:207], v[68:71]
    ds_read_b128 v[16:19], v13 offset:0
    v_mfma_f32_16x16x32_bf16 v[72:75], v[136:139], v[204:207], v[72:75]
    ds_read_b128 v[20:23], v13 offset:1024
    v_mfma_f32_16x16x32_bf16 v[76:79], v[140:143], v[204:207], v[76:79]
    s_waitcnt vmcnt(9)
    ds_read_b128 v[24:27], v13 offset:2048
    v_mfma_f32_16x16x32_bf16 v[48:51], v[144:147], v[208:211], v[48:51]
    ds_read_b128 v[28:31], v13 offset:3072
    v_mfma_f32_16x16x32_bf16 v[52:55], v[148:151], v[208:211], v[52:55]
    ds_read_b128 v[32:35], v13 offset:4096
    v_mfma_f32_16x16x32_bf16 v[56:59], v[152:155], v[208:211], v[56:59]
    ds_read_b128 v[36:39], v13 offset:5120
    v_mfma_f32_16x16x32_bf16 v[60:63], v[156:159], v[208:211], v[60:63]
    s_waitcnt vmcnt(8)
    ds_read_b128 v[40:43], v13 offset:6144
    v_mfma_f32_16x16x32_bf16 v[64:67], v[144:147], v[212:215], v[64:67]
    ds_read_b128 v[44:47], v13 offset:7168
    v_mfma_f32_16x16x32_bf16 v[68:71], v[148:151], v[212:215], v[68:71]
    s_waitcnt lgkmcnt(4)
    v_add_f32 v16, v16, v24
    v_add_f32 v17, v17, v25
    v_add_f32 v18, v18, v26
    v_add_f32 v19, v19, v27
    v_add_f32 v20, v20, v28
    v_add_f32 v21, v21, v29
    v_add_f32 v22, v22, v30
    v_add_f32 v23, v23, v31
    v_mfma_f32_16x16x32_bf16 v[72:75], v[152:155], v[212:215], v[72:75]
    s_waitcnt lgkmcnt(2)
    v_add_f32 v16, v16, v32
    v_add_f32 v17, v17, v33
    v_add_f32 v18, v18, v34
    v_add_f32 v19, v19, v35
    v_add_f32 v20, v20, v36
    v_add_f32 v21, v21, v37
    v_add_f32 v22, v22, v38
    v_add_f32 v23, v23, v39
    v_mfma_f32_16x16x32_bf16 v[76:79], v[156:159], v[212:215], v[76:79]
    s_waitcnt vmcnt(7)
    s_waitcnt lgkmcnt(0)
    v_add_f32 v16, v16, v40
    v_add_f32 v17, v17, v41
    v_add_f32 v18, v18, v42
    v_add_f32 v19, v19, v43
    v_add_f32 v20, v20, v44
    v_add_f32 v21, v21, v45
    v_add_f32 v22, v22, v46
    v_add_f32 v23, v23, v47
    v_mfma_f32_16x16x32_bf16 v[48:51], v[160:163], v[216:219], v[48:51]
    v_min_u32 v16, -2, v16
    v_min_u32 v17, -2, v17
    v_min_u32 v18, -2, v18
    v_min_u32 v19, -2, v19
    v_min_u32 v20, -2, v20
    v_min_u32 v21, -2, v21
    v_min_u32 v22, -2, v22
    v_min_u32 v23, -2, v23
    v_mfma_f32_16x16x32_bf16 v[52:55], v[164:167], v[216:219], v[52:55]
    buffer_store_dwordx4 v[16:19], v236, s[32:35], 0 offen offset:0 sc1
    v_mfma_f32_16x16x32_bf16 v[56:59], v[168:171], v[216:219], v[56:59]
    buffer_store_dwordx4 v[20:23], v236, s[32:35], 0 offen offset:1024 sc1
    v_mfma_f32_16x16x32_bf16 v[60:63], v[172:175], v[216:219], v[60:63]
    s_waitcnt vmcnt(8)
    v_add_u32 v12, 65536, v12
    v_add_u32 v13, 65536, v13
    v_mfma_f32_16x16x32_bf16 v[64:67], v[160:163], v[220:223], v[64:67]
    v_mfma_f32_16x16x32_bf16 v[68:71], v[164:167], v[220:223], v[68:71]
    v_mfma_f32_16x16x32_bf16 v[72:75], v[168:171], v[220:223], v[72:75]
    v_mfma_f32_16x16x32_bf16 v[76:79], v[172:175], v[220:223], v[76:79]
    s_waitcnt vmcnt(7)
    v_mfma_f32_16x16x32_bf16 v[48:51], v[176:179], v[224:227], v[48:51]
    v_mfma_f32_16x16x32_bf16 v[52:55], v[180:183], v[224:227], v[52:55]
    v_mfma_f32_16x16x32_bf16 v[56:59], v[184:187], v[224:227], v[56:59]
    v_mfma_f32_16x16x32_bf16 v[60:63], v[188:191], v[224:227], v[60:63]
    s_waitcnt vmcnt(6)
    v_mfma_f32_16x16x32_bf16 v[48:51], v[80:83], v[228:231], v[48:51]
    v_mfma_f32_16x16x32_bf16 v[52:55], v[84:87], v[228:231], v[52:55]
    v_mfma_f32_16x16x32_bf16 v[56:59], v[88:91], v[228:231], v[56:59]
    v_mfma_f32_16x16x32_bf16 v[60:63], v[92:95], v[228:231], v[60:63]
    s_waitcnt vmcnt(5)
    v_mfma_f32_16x16x32_bf16 v[48:51], v[96:99], v[192:195], v[48:51]
    v_mfma_f32_16x16x32_bf16 v[52:55], v[100:103], v[192:195], v[52:55]
    v_mfma_f32_16x16x32_bf16 v[56:59], v[104:107], v[192:195], v[56:59]
    v_mfma_f32_16x16x32_bf16 v[60:63], v[108:111], v[192:195], v[60:63]
    s_waitcnt vmcnt(4)
    v_mfma_f32_16x16x32_bf16 v[64:67], v[176:179], v[196:199], v[64:67]
    v_mfma_f32_16x16x32_bf16 v[68:71], v[180:183], v[196:199], v[68:71]
    v_mfma_f32_16x16x32_bf16 v[72:75], v[184:187], v[196:199], v[72:75]
    v_mfma_f32_16x16x32_bf16 v[76:79], v[188:191], v[196:199], v[76:79]
    s_waitcnt vmcnt(3)
    v_mfma_f32_16x16x32_bf16 v[64:67], v[80:83], v[112:115], v[64:67]
    v_mfma_f32_16x16x32_bf16 v[68:71], v[84:87], v[112:115], v[68:71]
    ds_write_b128 v12, v[48:51] offset:0
    v_mfma_f32_16x16x32_bf16 v[72:75], v[88:91], v[112:115], v[72:75]
    v_mfma_f32_16x16x32_bf16 v[76:79], v[92:95], v[112:115], v[76:79]
    s_waitcnt vmcnt(2)
    ds_write_b128 v12, v[52:55] offset:1024
    v_mfma_f32_16x16x32_bf16 v[64:67], v[96:99], v[116:119], v[64:67]
    v_mfma_f32_16x16x32_bf16 v[68:71], v[100:103], v[116:119], v[68:71]
    ds_write_b128 v12, v[56:59] offset:8192
    v_mfma_f32_16x16x32_bf16 v[72:75], v[104:107], v[116:119], v[72:75]
    v_mfma_f32_16x16x32_bf16 v[76:79], v[108:111], v[116:119], v[76:79]
    ds_write_b128 v12, v[60:63] offset:9216
    buffer_load_dwordx4 v[112:115], v236, s[20:23], 0 offen offset:0 sc1
    buffer_load_dwordx4 v[116:119], v236, s[20:23], 0 offen offset:1024 sc1
    s_nop 0
    ds_write_b128 v12, v[64:67] offset:16384
    ds_write_b128 v12, v[68:71] offset:17408
    s_nop 0
    ds_write_b128 v12, v[72:75] offset:24576
    ds_write_b128 v12, v[76:79] offset:25600
    s_waitcnt lgkmcnt(0)
    s_barrier
    ds_read_b128 v[80:83], v13 offset:0
    ds_read_b128 v[84:87], v13 offset:1024
    ds_read_b128 v[88:91], v13 offset:2048
    ds_read_b128 v[92:95], v13 offset:3072
    ds_read_b128 v[96:99], v13 offset:4096
    ds_read_b128 v[100:103], v13 offset:5120
    ds_read_b128 v[104:107], v13 offset:6144
    ds_read_b128 v[108:111], v13 offset:7168
    s_waitcnt lgkmcnt(4)
    v_add_f32 v80, v80, v88
    v_add_f32 v81, v81, v89
    v_add_f32 v82, v82, v90
    v_add_f32 v83, v83, v91
    v_add_f32 v84, v84, v92
    v_add_f32 v85, v85, v93
    v_add_f32 v86, v86, v94
    v_add_f32 v87, v87, v95
    s_waitcnt lgkmcnt(2)
    v_add_f32 v80, v80, v96
    v_add_f32 v81, v81, v97
    v_add_f32 v82, v82, v98
    v_add_f32 v83, v83, v99
    v_add_f32 v84, v84, v100
    v_add_f32 v85, v85, v101
    v_add_f32 v86, v86, v102
    v_add_f32 v87, v87, v103
    s_waitcnt lgkmcnt(0)
    v_add_f32 v80, v80, v104
    v_add_f32 v81, v81, v105
    v_add_f32 v82, v82, v106
    v_add_f32 v83, v83, v107
    v_add_f32 v84, v84, v108
    v_add_f32 v85, v85, v109
    v_add_f32 v86, v86, v110
    v_add_f32 v87, v87, v111
    s_waitcnt vmcnt(0)
    v_max3_u32 v232, v112, v113, v114
    v_max3_u32 v233, v115, v116, v117
    v_max3_u32 v232, v232, v118, v119
    v_max_u32 v232, v232, v233
    v_cmp_eq_u32 vcc, -1, v232
    s_cbranch_vccz L_gox_o
L_pollx_o:
    buffer_load_dwordx4 v[112:115], v236, s[20:23], 0 offen offset:0 sc1
    buffer_load_dwordx4 v[116:119], v236, s[20:23], 0 offen offset:1024 sc1
    s_waitcnt vmcnt(0)
    v_max3_u32 v232, v112, v113, v114
    v_max3_u32 v233, v115, v116, v117
    v_max3_u32 v232, v232, v118, v119
    v_max_u32 v232, v232, v233
    v_cmp_eq_u32 vcc, -1, v232
    s_cbranch_vccz L_gox_o
    s_sleep 1
    s_sub_u32 s95, s95, 1
    s_cmp_gt_i32 s95, 0
    s_cbranch_scc1 L_pollx_o
L_gox_o:
    v_add_f32 v80, v80, v112
    v_add_f32 v81, v81, v113
    v_add_f32 v82, v82, v114
    v_add_f32 v83, v83, v115
    v_add_f32 v84, v84, v116
    v_add_f32 v85, v85, v117
    v_add_f32 v86, v86, v118
    v_add_f32 v87, v87, v119
    v_cvt_pk_bf16_f32 v88, v80, v81
    v_cvt_pk_bf16_f32 v89, v82, v83
    v_cvt_pk_bf16_f32 v90, v84, v85
    v_cvt_pk_bf16_f32 v91, v86, v87
    buffer_store_dwordx2 v[88:89], v246, s[44:47], 0 offen
    buffer_store_dwordx2 v[90:91], v246, s[44:47], 0 offen offset:32
L_end:
    s_endpgm
L_rare_1:
    s_call_b64 s[76:77], L_fix_1
    s_branch L_back_1
L_rare_2:
    s_call_b64 s[76:77], L_fix_0
    s_branch L_back_2
L_rare_3:
    s_call_b64 s[76:77], L_fix_1
    s_branch L_back_3
L_rare_4:
    s_call_b64 s[76:77], L_fix_0
    s_branch L_back_4
L_rare_5:
    s_call_b64 s[76:77], L_fix_1
    s_branch L_back_5
L_rare_6:
    s_call_b64 s[76:77], L_fix_0
    s_branch L_back_6
L_rare_7:
    s_call_b64 s[76:77], L_fix_1
    s_branch L_back_7
L_rare_8:
    s_call_b64 s[76:77], L_fix_0
    s_branch L_back_8
L_rare_9:
    s_call_b64 s[76:77], L_fix_1
    s_branch L_back_9
L_rare_10:
    s_call_b64 s[76:77], L_fix_0
    s_branch L_back_10
L_rare_11:
    s_call_b64 s[76:77], L_fix_1
    s_branch L_back_11
L_rare_12:
    s_call_b64 s[76:77], L_fix_0
    s_branch L_back_12
L_rare_13:
    s_call_b64 s[76:77], L_fix_1
    s_branch L_back_13
L_rare_14:
    s_call_b64 s[76:77], L_fix_0
    s_branch L_back_14
L_rare_15:
    s_call_b64 s[76:77], L_fix_1
    s_branch L_back_15
L_fix_0:
    s_nop 15
    v_max3_f32 v251, v112, v113, v114
    v_max3_f32 v252, v120, v121, v122
    v_max3_f32 v251, v251, v115, v116
    v_max3_f32 v252, v252, v123, v124
    v_max3_f32 v251, v251, v117, v118
    v_max3_f32 v252, v252, v125, v126
    v_max_f32 v251, v251, v119
    v_max_f32 v252, v252, v127
    v_mov_b32 v232, v251
    v_mov_b32 v233, v252
    s_nop 0
    v_permlane32_swap_b32 v251, v232
    v_permlane32_swap_b32 v252, v233
    v_max_f32 v251, v251, v232
    v_max_f32 v252, v252, v233
    v_mov_b32 v232, v251
    v_mov_b32 v233, v252
    s_nop 0
    v_permlane16_swap_b32 v251, v232
    v_permlane16_swap_b32 v252, v233
    v_max_f32 v251, v251, v232
    v_max_f32 v252, v252, v233
    v_add_f32 v251, s74, v251
    v_max_f32 v251, 0, v251
    v_sub_f32 v234, 0, v251
    v_exp_f32 v234, v234
    v_add_f32 v252, s74, v252
    v_max_f32 v252, 0, v252
    v_sub_f32 v235, 0, v252
    v_exp_f32 v235, v235
    v_sub_f32 v112, v112, v251
    v_sub_f32 v128, v128, v251
    v_sub_f32 v113, v113, v251
    v_sub_f32 v129, v129, v251
    v_sub_f32 v114, v114, v251
    v_sub_f32 v130, v130, v251
    v_sub_f32 v115, v115, v251
    v_sub_f32 v131, v131, v251
    v_sub_f32 v116, v116, v251
    v_sub_f32 v132, v132, v251
    v_sub_f32 v117, v117, v251
    v_sub_f32 v133, v133, v251
    v_sub_f32 v118, v118, v251
    v_sub_f32 v134, v134, v251
    v_sub_f32 v119, v119, v251
    v_sub_f32 v135, v135, v251
    v_sub_f32 v120, v120, v252
    v_sub_f32 v136, v136, v252
    v_sub_f32 v121, v121, v252
    v_sub_f32 v137, v137, v252
    v_sub_f32 v122, v122, v252
    v_sub_f32 v138, v138, v252
    v_sub_f32 v123, v123, v252
    v_sub_f32 v139, v139, v252
    v_sub_f32 v124, v124, v252
    v_sub_f32 v140, v140, v252
    v_sub_f32 v125, v125, v252
    v_sub_f32 v141, v141, v252
    v_sub_f32 v126, v126, v252
    v_sub_f32 v142, v142, v252
    v_sub_f32 v127, v127, v252
    v_sub_f32 v143, v143, v252
    v_sub_f32 v160, v160, v251
    v_sub_f32 v161, v161, v251
    v_sub_f32 v162, v162, v251
    v_sub_f32 v163, v163, v251
    v_sub_f32 v164, v164, v252
    v_sub_f32 v165, v165, v252
    v_sub_f32 v166, v166, v252
    v_sub_f32 v167, v167, v252
    v_mul_f32 v216, v216, v234
    v_mul_f32 v217, v217, v234
    v_mul_f32 v218, v218, v234
    v_mul_f32 v219, v219, v234
    v_mul_f32 v220, v220, v235
    v_mul_f32 v221, v221, v235
    v_mul_f32 v222, v222, v235
    v_mul_f32 v223, v223, v235
    v_mul_f32 v16, v16, v234
    v_mul_f32 v17, v17, v234
    v_mul_f32 v18, v18, v234
    v_mul_f32 v19, v19, v234
    v_mul_f32 v20, v20, v235
    v_mul_f32 v21, v21, v235
    v_mul_f32 v22, v22, v235
    v_mul_f32 v23, v23, v235
    v_mul_f32 v24, v24, v234
    v_mul_f32 v25, v25, v234
    v_mul_f32 v26, v26, v234
    v_mul_f32 v27, v27, v234
    v_mul_f32 v28, v28, v235
    v_mul_f32 v29, v29, v235
    v_mul_f32 v30, v30, v235
    v_mul_f32 v31, v31, v235
    v_mul_f32 v32, v32, v234
    v_mul_f32 v33, v33, v234
    v_mul_f32 v34, v34, v234
    v_mul_f32 v35, v35, v234
    v_mul_f32 v36, v36, v235
    v_mul_f32 v37, v37, v235
    v_mul_f32 v38, v38, v235
    v_mul_f32 v39, v39, v235
    v_mul_f32 v40, v40, v234
    v_mul_f32 v41, v41, v234
    v_mul_f32 v42, v42, v234
    v_mul_f32 v43, v43, v234
    v_mul_f32 v44, v44, v235
    v_mul_f32 v45, v45, v235
    v_mul_f32 v46, v46, v235
    v_mul_f32 v47, v47, v235
    v_mul_f32 v48, v48, v234
    v_mul_f32 v49, v49, v234
    v_mul_f32 v50, v50, v234
    v_mul_f32 v51, v51, v234
    v_mul_f32 v52, v52, v235
    v_mul_f32 v53, v53, v235
    v_mul_f32 v54, v54, v235
    v_mul_f32 v55, v55, v235
    v_mul_f32 v56, v56, v234
    v_mul_f32 v57, v57, v234
    v_mul_f32 v58, v58, v234
    v_mul_f32 v59, v59, v234
    v_mul_f32 v60, v60, v235
    v_mul_f32 v61, v61, v235
    v_mul_f32 v62, v62, v235
    v_mul_f32 v63, v63, v235
    v_mul_f32 v64, v64, v234
    v_mul_f32 v65, v65, v234
    v_mul_f32 v66, v66, v234
    v_mul_f32 v67, v67, v234
    v_mul_f32 v68, v68, v235
    v_mul_f32 v69, v69, v235
    v_mul_f32 v70, v70, v235
    v_mul_f32 v71, v71, v235
    v_mul_f32 v72, v72, v234
    v_mul_f32 v73, v73, v234
    v_mul_f32 v74, v74, v234
    v_mul_f32 v75, v75, v234
    v_mul_f32 v76, v76, v235
    v_mul_f32 v77, v77, v235
    v_mul_f32 v78, v78, v235
    v_mul_f32 v79, v79, v235
    v_exp_f32 v212, v112
    v_exp_f32 v213, v113
    v_exp_f32 v214, v114
    v_exp_f32 v215, v115
    v_cvt_pk_bf16_f32 v144, v212, v213
    v_exp_f32 v212, v116
    v_exp_f32 v213, v117
    v_cvt_pk_bf16_f32 v145, v214, v215
    v_exp_f32 v214, v118
    v_exp_f32 v215, v119
    v_cvt_pk_bf16_f32 v146, v212, v213
    v_exp_f32 v212, v120
    v_exp_f32 v213, v121
    v_cvt_pk_bf16_f32 v147, v214, v215
    v_exp_f32 v214, v122
    v_exp_f32 v215, v123
    v_cvt_pk_bf16_f32 v148, v212, v213
    v_exp_f32 v212, v124
    v_exp_f32 v213, v125
    v_cvt_pk_bf16_f32 v149, v214, v215
    v_exp_f32 v214, v126
    v_exp_f32 v215, v127
    v_cvt_pk_bf16_f32 v150, v212, v213
    v_cvt_pk_bf16_f32 v151, v214, v215
    s_nop 3
    s_setpc_b64 s[76:77]
L_fix_1:
    s_nop 15
    v_max3_f32 v251, v128, v129, v130
    v_max3_f32 v252, v136, v137, v138
    v_max3_f32 v251, v251, v131, v132
    v_max3_f32 v252, v252, v139, v140
    v_max3_f32 v251, v251, v133, v134
    v_max3_f32 v252, v252, v141, v142
    v_max_f32 v251, v251, v135
    v_max_f32 v252, v252, v143
    v_mov_b32 v232, v251
    v_mov_b32 v233, v252
    s_nop 0
    v_permlane32_swap_b32 v251, v232
    v_permlane32_swap_b32 v252, v233
    v_max_f32 v251, v251, v232
    v_max_f32 v252, v252, v233
    v_mov_b32 v232, v251
    v_mov_b32 v233, v252
    s_nop 0
    v_permlane16_swap_b32 v251, v232
    v_permlane16_swap_b32 v252, v233
    v_max_f32 v251, v251, v232
    v_max_f32 v252, v252, v233
    v_add_f32 v251, s74, v251
    v_max_f32 v251, 0, v251
    v_sub_f32 v234, 0, v251
    v_exp_f32 v234, v234
    v_add_f32 v252, s74, v252
    v_max_f32 v252, 0, v252
    v_sub_f32 v235, 0, v252
    v_exp_f32 v235, v235
    v_sub_f32 v128, v128, v251
    v_sub_f32 v112, v112, v251
    v_sub_f32 v129, v129, v251
    v_sub_f32 v113, v113, v251
    v_sub_f32 v130, v130, v251
    v_sub_f32 v114, v114, v251
    v_sub_f32 v131, v131, v251
    v_sub_f32 v115, v115, v251
    v_sub_f32 v132, v132, v251
    v_sub_f32 v116, v116, v251
    v_sub_f32 v133, v133, v251
    v_sub_f32 v117, v117, v251
    v_sub_f32 v134, v134, v251
    v_sub_f32 v118, v118, v251
    v_sub_f32 v135, v135, v251
    v_sub_f32 v119, v119, v251
    v_sub_f32 v136, v136, v252
    v_sub_f32 v120, v120, v252
    v_sub_f32 v137, v137, v252
    v_sub_f32 v121, v121, v252
    v_sub_f32 v138, v138, v252
    v_sub_f32 v122, v122, v252
    v_sub_f32 v139, v139, v252
    v_sub_f32 v123, v123, v252
    v_sub_f32 v140, v140, v252
    v_sub_f32 v124, v124, v252
    v_sub_f32 v141, v141, v252
    v_sub_f32 v125, v125, v252
    v_sub_f32 v142, v142, v252
    v_sub_f32 v126, v126, v252
    v_sub_f32 v143, v143, v252
    v_sub_f32 v127, v127, v252
    v_sub_f32 v160, v160, v251
    v_sub_f32 v161, v161, v251
    v_sub_f32 v162, v162, v251
    v_sub_f32 v163, v163, v251
    v_sub_f32 v164, v164, v252
    v_sub_f32 v165, v165, v252
    v_sub_f32 v166, v166, v252
    v_sub_f32 v167, v167, v252
    v_mul_f32 v216, v216, v234
    v_mul_f32 v217, v217, v234
    v_mul_f32 v218, v218, v234
    v_mul_f32 v219, v219, v234
    v_mul_f32 v220, v220, v235
    v_mul_f32 v221, v221, v235
    v_mul_f32 v222, v222, v235
    v_mul_f32 v223, v223, v235
    v_mul_f32 v16, v16, v234
    v_mul_f32 v17, v17, v234
    v_mul_f32 v18, v18, v234
    v_mul_f32 v19, v19, v234
    v_mul_f32 v20, v20, v235
    v_mul_f32 v21, v21, v235
    v_mul_f32 v22, v22, v235
    v_mul_f32 v23, v23, v235
    v_mul_f32 v24, v24, v234
    v_mul_f32 v25, v25, v234
    v_mul_f32 v26, v26, v234
    v_mul_f32 v27, v27, v234
    v_mul_f32 v28, v28, v235
    v_mul_f32 v29, v29, v235
    v_mul_f32 v30, v30, v235
    v_mul_f32 v31, v31, v235
    v_mul_f32 v32, v32, v234
    v_mul_f32 v33, v33, v234
    v_mul_f32 v34, v34, v234
    v_mul_f32 v35, v35, v234
    v_mul_f32 v36, v36, v235
    v_mul_f32 v37, v37, v235
    v_mul_f32 v38, v38, v235
    v_mul_f32 v39, v39, v235
    v_mul_f32 v40, v40, v234
    v_mul_f32 v41, v41, v234
    v_mul_f32 v42, v42, v234
    v_mul_f32 v43, v43, v234
    v_mul_f32 v44, v44, v235
    v_mul_f32 v45, v45, v235
    v_mul_f32 v46, v46, v235
    v_mul_f32 v47, v47, v235
    v_mul_f32 v48, v48, v234
    v_mul_f32 v49, v49, v234
    v_mul_f32 v50, v50, v234
    v_mul_f32 v51, v51, v234
    v_mul_f32 v52, v52, v235
    v_mul_f32 v53, v53, v235
    v_mul_f32 v54, v54, v235
    v_mul_f32 v55, v55, v235
    v_mul_f32 v56, v56, v234
    v_mul_f32 v57, v57, v234
    v_mul_f32 v58, v58, v234
    v_mul_f32 v59, v59, v234
    v_mul_f32 v60, v60, v235
    v_mul_f32 v61, v61, v235
    v_mul_f32 v62, v62, v235
    v_mul_f32 v63, v63, v235
    v_mul_f32 v64, v64, v234
    v_mul_f32 v65, v65, v234
    v_mul_f32 v66, v66, v234
    v_mul_f32 v67, v67, v234
    v_mul_f32 v68, v68, v235
    v_mul_f32 v69, v69, v235
    v_mul_f32 v70, v70, v235
    v_mul_f32 v71, v71, v235
    v_mul_f32 v72, v72, v234
    v_mul_f32 v73, v73, v234
    v_mul_f32 v74, v74, v234
    v_mul_f32 v75, v75, v234
    v_mul_f32 v76, v76, v235
    v_mul_f32 v77, v77, v235
    v_mul_f32 v78, v78, v235
    v_mul_f32 v79, v79, v235
    v_exp_f32 v212, v128
    v_exp_f32 v213, v129
    v_exp_f32 v214, v130
    v_exp_f32 v215, v131
    v_cvt_pk_bf16_f32 v152, v212, v213
    v_exp_f32 v212, v132
    v_exp_f32 v213, v133
    v_cvt_pk_bf16_f32 v153, v214, v215
    v_exp_f32 v214, v134
    v_exp_f32 v215, v135
    v_cvt_pk_bf16_f32 v154, v212, v213
    v_exp_f32 v212, v136
    v_exp_f32 v213, v137
    v_cvt_pk_bf16_f32 v155, v214, v215
    v_exp_f32 v214, v138
    v_exp_f32 v215, v139
    v_cvt_pk_bf16_f32 v156, v212, v213
    v_exp_f32 v212, v140
    v_exp_f32 v213, v141
    v_cvt_pk_bf16_f32 v157, v214, v215
    v_exp_f32 v214, v142
    v_exp_f32 v215, v143
    v_cvt_pk_bf16_f32 v158, v212, v213
    v_cvt_pk_bf16_f32 v159, v214, v215
    s_nop 3
    s_setpc_b64 s[76:77]
L_code_end:
.section .rodata,"a"
.p2align 6
.amdhsa_kernel standalone__gqa_block_cached__near_ridge_kernel
  .amdhsa_next_free_vgpr 256
  .amdhsa_next_free_sgpr 102
  .amdhsa_accum_offset 256
  .amdhsa_group_segment_fixed_size 0
  .amdhsa_kernarg_size 64
  .amdhsa_user_sgpr_count 2
  .amdhsa_user_sgpr_kernarg_segment_ptr 1
  .amdhsa_system_sgpr_workgroup_id_x 1
.end_amdhsa_kernel
```
